```python
import torch

def _softmax(x, axis=-1):
    return torch.softmax(x, dim=axis)

def _gelu(x):
    return torch.nn.functional.gelu(x, approximate='tanh')

def _silu(x):
    return torch.nn.functional.silu(x)

def _sigmoid(x):
    return torch.sigmoid(x)

def _layernorm(x, axis=-1, eps=1e-05):
    m = x.mean(dim=axis, keepdim=True)
    v = x.var(dim=axis, keepdim=True, unbiased=False)
    return (x - m) / torch.sqrt(v + eps)

def _scatter_add(tgt, idx, src, axis=0):
    return tgt.clone().index_add_(axis, idx, src)

def _segment_sum(src, seg, n):
    out = torch.zeros((n,) + src.shape[1:], dtype=src.dtype)
    return out.index_add_(0, seg, src)

def _pad(x, pw):
    flat = tuple((v for pair in reversed(pw) for v in pair))
    return torch.nn.functional.pad(x, flat)
kernel_name = 'adaLN_cond__mha_block__dense_activation_relu__prompt'

def setup_inputs():

    _w = lambda a: (lambda t: t.to(torch.bfloat16) if t.is_floating_point() else t)(torch.as_tensor(a))

    def _A_setup():
        B, S, D, H = (1, 2048, 512, 32)
        return {'x': _w((lambda *s: torch.randn(*s, dtype=torch.bfloat16) * 0.05)(B, S, D)), 'wqkv': _w((lambda *s: torch.randn(*s, dtype=torch.bfloat16) * 0.05)(D, 3 * D)), 'wo': _w((lambda *s: torch.randn(*s, dtype=torch.bfloat16) * 0.05)(D, D))}
    _A_in = _A_setup()

    def _B_setup():
        B, S, D, Dff = (1, 2048, 512, 1792)
        return {'x': _w((lambda *s: torch.randn(*s, dtype=torch.bfloat16) * 0.05)(B, S, D)), 'w1': _w((lambda *s: torch.randn(*s, dtype=torch.bfloat16) * 0.05)(D, Dff)), 'w2': _w((lambda *s: torch.randn(*s, dtype=torch.bfloat16) * 0.05)(Dff, D))}
    _B_in = _B_setup()
    return {'A_x': _A_in['x'], 'A_wqkv': _A_in['wqkv'], 'A_wo': _A_in['wo'], 'B_x': _B_in['x'], 'B_w1': _B_in['w1'], 'B_w2': _B_in['w2'], 'c': _w((lambda *s: torch.randn(*s, dtype=torch.bfloat16) * 0.1)(1, 512) * 8.0), 'w_mod': _w((lambda *s: torch.randn(*s, dtype=torch.bfloat16) * 0.1)(512, 6 * 512) * 512 ** (-0.5) * 8.0)}

def reference(A_x, A_wqkv, A_wo, B_x, B_w1, B_w2, c, w_mod):

    def _A_ref(x, wqkv, wo):
        B, S, D = x.shape
        H = 32
        Dh = D // H
        qkv = (lambda x, *d: x.permute(*d))((x @ wqkv).reshape(B, S, 3, H, Dh), 2, 0, 3, 1, 4)
        q, k, v = (qkv[0], qkv[1], qkv[2])
        scores = torch.einsum('bhqd,bhkd->bhqk', q, k) * Dh ** (-0.5)
        p = _softmax(scores, axis=-1)
        o = torch.einsum('bhqk,bhkd->bhqd', p, v)
        return (lambda x, *d: x.permute(*d))(o, 0, 2, 1, 3).reshape(B, S, D) @ wo

    def _B_ref(x, w1, w2):
        h = torch.einsum('bsd,df->bsf', x, w1)
        zero = torch.zeros_like(h)
        h = torch.maximum(h, zero)
        return torch.einsum('bsf,fd->bsd', h, w2)
    x = A_x
    mod = (_silu(c) @ w_mod).reshape(c.shape[0], 6, 1, -1)
    sa, ca, ga, sb, cb, gb = (mod[:, 0].clone(), mod[:, 1].clone(), mod[:, 2].clone(), mod[:, 3].clone(), mod[:, 4].clone(), mod[:, 5].clone())
    h = _layernorm(x, axis=-1) * (1 + ca) + sa
    x = x + ga * _A_ref(h, A_wqkv, A_wo)
    h = _layernorm(x, axis=-1) * (1 + cb) + sb
    x = x + gb * _B_ref(h, B_w1, B_w2)
    return x
```

```asm
; @launch grid=(256,1,1) block=(512,1,1) lds=163840
.amdgcn_target "amdgcn-amd-amdhsa--gfx950"
.text
.globl adaLN_cond__mha_block__dense_activation_relu__prompt_kernel
.p2align 8
.type adaLN_cond__mha_block__dense_activation_relu__prompt_kernel,@function
adaLN_cond__mha_block__dense_activation_relu__prompt_kernel:
    s_cmp_ge_u32 s2, 256
    s_cbranch_scc1 L_end
    s_load_dwordx16 s[64:79], s[0:1], 0
    s_load_dwordx4 s[80:83], s[0:1], 64
    s_load_dwordx2 s[84:85], s[0:1], 80
    v_lshrrev_b32 v2, 6, v0
    v_mov_b32 v6, v0
    v_and_b32 v0, 63, v0
    s_and_b32 s0, s2, 7
    v_readfirstlane_b32 s5, v2
    v_lshlrev_b32 v1, 4, v0
    s_lshr_b32 s1, s2, 3
    s_mul_i32 s60, s1, 98304
    s_lshl_b32 s48, s0, 7
    s_add_u32 s60, s60, s48
    s_and_b32 s48, s5, 3
    s_lshl_b32 s48, s48, 11
    s_add_u32 s60, s60, s48
    s_lshl_b32 s61, s1, 5
    v_lshrrev_b32 v157, 3, v0
    v_mul_u32_u24 v156, 6144, v157
    v_lshlrev_b32 v157, 1, v157
    v_and_b32 v152, 112, v1
    v_add_u32 v156, v156, v152
    s_add_u32 s57, s60, 49152
    s_mov_b32 s30, 3145728
    s_mov_b32 s31, 131072
    s_mov_b32 s26, 1024
    s_mov_b32 s27, 131072
    s_getpc_b64 s[50:51]
    s_lshl_b32 s52, s1, 11
    v_bfe_u32 v2, v6, 2, 9
    v_lshlrev_b32 v2, 4, v2
    v_add_u32 v2, s52, v2
    s_mov_b32 s52, L_end-L_pc-16
    v_min_u32 v2, s52, v2
L_pc:
    global_load_dword v73, v2, s[50:51]
    s_cmp_lg_u32 s5, 0
    s_waitcnt lgkmcnt(0)
    s_mov_b64 s[28:29], s[78:79]
    s_mov_b64 s[24:25], s[76:77]
    s_cbranch_scc1 L_nog1
    buffer_load_dwordx4 v[136:139], v156, s[28:31], s60 offen offset:0 nt
    buffer_load_dwordx4 v[140:143], v156, s[28:31], s57 offen offset:0 nt
    buffer_load_dwordx4 v[144:147], v156, s[28:31], s60 offen offset:1024 nt
    buffer_load_dwordx4 v[148:151], v156, s[28:31], s57 offen offset:1024 nt
    buffer_load_ushort v152, v157, s[24:27], s61 offen offset:0
    buffer_load_ushort v154, v157, s[24:27], s61 offen offset:16
L_nog1:
    s_load_dwordx2 s[40:41], s[84:85], 12288
    s_mov_b64 s[16:17], s[66:67]
    s_mov_b64 s[12:13], s[64:65]
    s_mov_b32 s44, 1
    s_cmp_lg_u32 s5, 4
    s_cbranch_scc1 L_nd1
    s_mov_b64 exec, 0
    s_call_b64 s[46:47], L_gemv
    s_mov_b64 exec, -1
L_nd1:
    s_cmp_lg_u32 s5, 5
    s_cbranch_scc1 L_nd2
    s_mov_b64 exec, 0
    s_call_b64 s[46:47], L_try
    s_mov_b64 exec, -1
L_nd2:
    s_mov_b32 s44, 0
    s_mov_b32 s18, 1572864
    s_mov_b32 s19, 131072
    s_mov_b32 s14, 2097152
    s_mov_b32 s15, 131072
    s_and_b32 s4, s0, 3
    s_lshl_b32 s4, s4, 3
    s_and_b32 s48, s1, 7
    s_add_u32 s4, s4, s48
    s_andn2_b32 s3, s0, 3
    s_lshr_b32 s48, s1, 3
    s_add_u32 s3, s3, s48
    s_lshl_b32 s63, s0, 5
    s_add_u32 s63, s63, s1
    s_lshl_b32 s91, s3, 18
    s_lshl_b32 s49, s5, 15
    s_add_u32 s91, s91, s49
    s_add_u32 s94, s1, s5
    s_and_b32 s94, s94, 7
    s_lshl_b32 s49, s94, 7
    s_add_u32 s91, s91, s49
    s_mul_i32 s93, s5, 10240
    s_add_u32 s93, s93, 81920
    v_lshrrev_b32 v2, 4, v0
    v_xor_b32 v2, v2, v0
    v_and_b32 v2, 7, v2
    v_lshrrev_b32 v3, 3, v0
    v_lshlrev_b32 v3, 10, v3
    v_lshl_add_u32 v120, v2, 4, v3
    v_xor_b32 v121, 64, v120
    v_add_u32 v121, 8192, v121
    v_and_b32 v2, 7, v0
    v_lshlrev_b32 v2, 3, v2
    s_mov_b32 s54, 8388864
    s_mov_b32 s55, 2164277568
    v_lshrrev_b64 v[2:3], v2, s[54:55]
    v_and_b32 v2, 255, v2
    v_lshlrev_b32 v2, 4, v2
    v_lshrrev_b32 v3, 4, v0
    v_lshl_add_u32 v2, v3, 5, v2
    v_bfe_u32 v3, v0, 3, 1
    v_mul_u32_u24 v3, 3072, v3
    v_add_u32 v5, v2, v3
    s_mul_i32 s48, s63, 6144
    s_lshl_b32 s49, s5, 7
    s_add_u32 s48, s48, s49
    s_mov_b32 s92, s48
    s_andn2_b32 s49, s0, 3
    s_lshl_b32 s49, s49, 8
    s_and_b32 s50, s63, 127
    s_lshl_b32 s50, s50, 3
    s_add_u32 s49, s49, s50
    s_add_u32 s49, s49, s5
    s_lshl_b32 s49, s49, 10
    s_mov_b32 s43, s49
    buffer_load_dwordx4 v[8:11], v5, s[16:19], s92 offen nt
    buffer_load_dwordx4 v[68:71], v1, s[12:15], s43 offen
    s_mov_b64 s[36:37], s[84:85]
    s_mov_b32 s38, 268435456
    s_mov_b32 s39, 131072
    s_lshl_b32 s90, s63, 10
    s_add_u32 s90, s90, 29360128
    s_cmp_lg_u32 s5, 1
    s_cbranch_scc1 L_notouch
    buffer_load_dwordx4 v[32:35], v1, s[36:39], s90 offen sc1
L_notouch:
    s_cmp_lg_u32 s5, 2
    s_cbranch_scc1 L_nosmt
    s_mul_i32 s49, s2, 384
    s_add_u32 s49, s49, 1441792
    v_min_u32 v2, 368, v1
    buffer_load_dword v72, v2, s[36:39], s49 offen sc1
L_nosmt:
    s_mov_b32 s58, 4278255360
    s_mov_b32 s59, 4278255360
    s_lshl_b32 s62, s5, 3
    s_add_u32 s62, s62, s0
    s_lshl_b32 s62, s62, 15
    s_add_u32 s62, s62, s61
    s_add_u32 s62, s62, 29360128
    v_bfe_u32 v2, v0, 1, 3
    v_lshrrev_b32 v3, 4, v0
    v_xor_b32 v2, v2, v3
    v_lshlrev_b32 v30, 16, v3
    v_and_b32 v3, 15, v0
    v_lshl_add_u32 v30, v3, 4, v30
    v_lshlrev_b32 v3, 7, v3
    v_lshl_add_u32 v2, v2, 4, v3
    v_add_u32 v122, s93, v2
    v_xor_b32 v123, 64, v122
    s_mov_b32 s8, 0
    s_mov_b32 s96, 0
    s_mov_b32 s97, 1065369472
    s_mov_b32 s98, 1212696648
    s_mov_b32 s99, 1212696648
    s_lshl_b32 s95, s5, 18
    s_lshl_b32 s48, s63, 8
    s_add_u32 s95, s95, s48
    s_add_u32 s95, s95, 20971520
    s_branch L_nog2
L_gemv:
    v_lshlrev_b32 v152, 16, v152
    v_lshlrev_b32 v154, 16, v154
    v_mul_f32 v153, 3216550459, v152
    v_mul_f32 v155, 3216550459, v154
    v_exp_f32 v153, v153
    v_exp_f32 v155, v155
    v_and_b32 v156, 7, v0
    v_add_f32 v153, 1.0, v153
    v_add_f32 v155, 1.0, v155
    v_rcp_f32 v153, v153
    v_rcp_f32 v155, v155
    v_lshlrev_b32 v156, 2, v156
    v_mul_f32 v152, v152, v153
    v_mul_f32 v154, v154, v155
    v_cvt_pk_bf16_f32 v152, v152, 0
    v_cvt_pk_bf16_f32 v154, v154, 0
    v_lshlrev_b32 v153, 16, v152
    v_lshlrev_b32 v155, 16, v154
    v_dot2_f32_bf16 v96, v136, v152, 0
    v_dot2_f32_bf16 v97, v136, v153, 0
    v_dot2_f32_bf16 v98, v137, v152, 0
    v_dot2_f32_bf16 v99, v137, v153, 0
    v_dot2_f32_bf16 v100, v138, v152, 0
    v_dot2_f32_bf16 v101, v138, v153, 0
    v_dot2_f32_bf16 v102, v139, v152, 0
    v_dot2_f32_bf16 v103, v139, v153, 0
    v_dot2_f32_bf16 v104, v144, v152, 0
    v_dot2_f32_bf16 v105, v144, v153, 0
    v_dot2_f32_bf16 v106, v145, v152, 0
    v_dot2_f32_bf16 v107, v145, v153, 0
    v_dot2_f32_bf16 v108, v146, v152, 0
    v_dot2_f32_bf16 v109, v146, v153, 0
    v_dot2_f32_bf16 v110, v147, v152, 0
    v_dot2_f32_bf16 v111, v147, v153, 0
    v_dot2_f32_bf16 v96, v140, v154, v96
    v_dot2_f32_bf16 v97, v140, v155, v97
    v_dot2_f32_bf16 v98, v141, v154, v98
    v_dot2_f32_bf16 v99, v141, v155, v99
    v_dot2_f32_bf16 v100, v142, v154, v100
    v_dot2_f32_bf16 v101, v142, v155, v101
    v_dot2_f32_bf16 v102, v143, v154, v102
    v_dot2_f32_bf16 v103, v143, v155, v103
    v_dot2_f32_bf16 v104, v148, v154, v104
    v_dot2_f32_bf16 v105, v148, v155, v105
    v_dot2_f32_bf16 v106, v149, v154, v106
    v_dot2_f32_bf16 v107, v149, v155, v107
    v_dot2_f32_bf16 v108, v150, v154, v108
    v_dot2_f32_bf16 v109, v150, v155, v109
    v_dot2_f32_bf16 v110, v151, v154, v110
    v_dot2_f32_bf16 v111, v151, v155, v111
    v_bfe_u32 v157, v0, 3, 2
    v_add_u32 v156, v157, v156
    v_lshrrev_b32 v157, 1, v0
    v_and_b32 v157, 16, v157
    v_permlane32_swap_b32 v96, v104
    v_permlane32_swap_b32 v97, v105
    v_permlane32_swap_b32 v98, v106
    v_permlane32_swap_b32 v99, v107
    v_permlane32_swap_b32 v100, v108
    v_permlane32_swap_b32 v101, v109
    v_permlane32_swap_b32 v102, v110
    v_permlane32_swap_b32 v103, v111
    v_add_f32 v96, v96, v104
    v_add_f32 v97, v97, v105
    v_add_f32 v98, v98, v106
    v_add_f32 v99, v99, v107
    v_add_f32 v100, v100, v108
    v_add_f32 v101, v101, v109
    v_add_f32 v102, v102, v110
    v_add_f32 v103, v103, v111
    v_lshl_add_u32 v152, v156, 5, v157
    v_lshl_add_u32 v156, v156, 10, v157
    v_permlane16_swap_b32 v96, v100
    v_permlane16_swap_b32 v97, v101
    v_permlane16_swap_b32 v98, v102
    v_permlane16_swap_b32 v99, v103
    v_add_f32 v96, v96, v100
    v_add_f32 v97, v97, v101
    v_add_f32 v98, v98, v102
    v_add_f32 v99, v99, v103
    v_mov_b32 v105, s6
    v_mov_b32 v107, s7
    v_add_f32_dpp v100, v96, v96 row_ror:8 row_mask:0xf bank_mask:0xf
    v_add_f32_dpp v101, v97, v97 row_ror:8 row_mask:0xf bank_mask:0xf
    v_add_f32_dpp v102, v98, v98 row_ror:8 row_mask:0xf bank_mask:0xf
    v_add_f32_dpp v103, v99, v99 row_ror:8 row_mask:0xf bank_mask:0xf
    s_and_b32 s57, s5, 3
    s_lshl_b32 s57, s57, 8
    s_add_u32 s57, s57, s63
    s_lshl_b32 s57, s57, 10
    s_add_u32 s57, s57, 30408704
    v_cndmask_b32 v104, v100, v102, s[58:59]
    v_cndmask_b32 v106, v101, v103, s[58:59]
    s_cmp_lg_u32 s44, 0
    s_cbranch_scc1 L_gemv_ret
    s_cmp_lg_u32 s5, 0
    s_cbranch_scc1 L_gemv_b
    buffer_store_dwordx4 v[104:107], v156, s[36:39], s62 offen
L_gemv_b:
    buffer_store_dwordx4 v[104:107], v152, s[36:39], s57 offen sc1
L_gemv_ret:
    s_setpc_b64 s[46:47]
L_try:
    v_cmp_ne_u32 vcc, s6, v33
    v_cmp_ne_u32 s[48:49], s7, v35
    s_nop 0
    s_or_b64 vcc, vcc, s[48:49]
    s_cbranch_scc1 L_try_no
    v_add_f32_dpp v33, v32, v32 quad_perm:[2,3,0,1] row_mask:0xf bank_mask:0xf
    v_add_f32_dpp v35, v34, v34 quad_perm:[2,3,0,1] row_mask:0xf bank_mask:0xf
    s_nop 0
    v_add_f32_dpp v32, v33, v33 row_ror:4 row_mask:0xf bank_mask:0xf
    v_add_f32_dpp v34, v35, v35 row_ror:4 row_mask:0xf bank_mask:0xf
    s_nop 0
    v_add_f32_dpp v33, v32, v32 row_ror:8 row_mask:0xf bank_mask:0xf
    v_add_f32_dpp v35, v34, v34 row_ror:8 row_mask:0xf bank_mask:0xf
    s_nop 1
    v_permlane32_swap_b32 v33, v35
    v_add_f32 v36, v33, v35
    v_mov_b32 v32, v36
    s_nop 1
    v_permlane16_swap_b32 v36, v32
    v_add_f32 v36, v36, v32
    v_cvt_pk_bf16_f32 v36, v36, v36
    v_and_b32 v36, 4294901760, v36
    s_nop 0
    v_readlane_b32 s48, v36, 1
    v_readlane_b32 s49, v36, 33
    v_readlane_b32 s54, v36, 0
    v_readlane_b32 s55, v36, 32
    v_mov_b32 v37, s48
    v_mov_b32 v38, s49
    v_mov_b32 v36, s54
    v_mov_b32 v39, s55
    v_cndmask_b32 v37, v37, v38, s[58:59]
    v_cndmask_b32 v36, v36, v39, s[58:59]
    v_add_f32 v37, 1.0, v37
    v_cvt_pk_bf16_f32 v37, v37, v37
    v_and_b32 v37, 4294901760, v37
    v_add_f32 v37, 562036736, v37
    v_rcp_f32 v38, v37
    v_mul_f32 v12, v12, v37
    v_mul_f32 v13, v13, v37
    v_mul_f32 v14, v14, v37
    v_mul_f32 v15, v15, v37
    v_mul_f32 v16, v16, v37
    v_mul_f32 v17, v17, v37
    v_mul_f32 v18, v18, v37
    v_mul_f32 v19, v19, v37
    v_mul_f32 v36, v36, v38
    v_cvt_pk_bf16_f32 v8, v12, v13
    v_cvt_pk_bf16_f32 v9, v14, v15
    v_cvt_pk_bf16_f32 v10, v16, v17
    v_cvt_pk_bf16_f32 v11, v18, v19
    v_cvt_pk_bf16_f32 v20, v36, 1.0
    v_cndmask_b32 v8, v8, v20, s[98:99]
    v_cndmask_b32 v9, v9, v21, s[98:99]
    v_cndmask_b32 v10, v10, v22, s[98:99]
    v_cndmask_b32 v11, v11, v23, s[98:99]
    s_cmp_lg_u32 s44, 0
    s_cbranch_scc1 L_try_no
    buffer_store_dwordx4 v[8:11], v30, s[36:39], s95 offen sc1
    s_mov_b32 s96, 1
L_try_no:
    s_setpc_b64 s[46:47]
L_nog2:
    s_mov_b64 s[32:33], s[80:81]
    s_mov_b32 s34, 2097152
    s_mov_b32 s35, 131072
    s_mov_b32 s22, 1835008
    s_mov_b32 s23, 131072
    s_mul_i32 s52, s2, 7
    s_add_u32 s52, s52, s5
    s_cmp_eq_u32 s5, 7
    s_cbranch_scc1 L_pwo
    s_cmp_ge_u32 s52, 896
    s_cbranch_scc1 L_pw2
    s_mov_b64 s[20:21], s[72:73]
    s_lshr_b32 s48, s52, 5
    s_and_b32 s49, s52, 31
    s_mul_i32 s69, s49, 57344
    s_lshl_b32 s50, s48, 7
    s_mov_b32 s70, 28672
    s_lshl_b32 s71, s48, 16
    s_lshl_b32 s49, s49, 10
    s_add_u32 s71, s71, 23068672
    s_mov_b32 s51, 32768
    s_mov_b32 s75, 0
    s_branch L_pdone
L_pw2:
    s_mov_b64 s[20:21], s[74:75]
    s_sub_u32 s48, s52, 896
    s_and_b32 s49, s48, 7
    s_lshr_b32 s48, s48, 3
    s_lshl_b32 s69, s48, 14
    s_lshl_b32 s50, s49, 7
    s_movk_i32 s70, 4096
    s_lshl_b32 s71, s49, 18
    s_lshl_b32 s49, s48, 11
    s_mul_i32 s48, s48, 4682
    s_lshr_b32 s48, s48, 16
    s_lshl_b32 s48, s48, 12
    s_add_u32 s71, s71, s48
    s_add_u32 s71, s71, 25165824
    s_movk_i32 s51, 1024
    s_mov_b32 s75, 1
    s_branch L_pdone
L_pwo:
    s_mov_b64 s[20:21], s[68:69]
    s_add_u32 s52, s2, 1792
    s_and_b32 s49, s2, 15
    s_lshr_b32 s48, s2, 4
    s_lshl_b32 s69, s49, 15
    s_lshl_b32 s50, s48, 6
    s_movk_i32 s70, 16384
    s_lshl_b32 s71, s48, 15
    s_lshl_b32 s49, s49, 10
    s_add_u32 s71, s71, 27262976
    s_movk_i32 s51, 16384
    s_mov_b32 s75, 2
L_pdone:
    s_add_u32 s69, s69, s50
    s_add_u32 s71, s71, s49
    s_add_u32 s72, s71, s51
    s_lshl_b32 s73, s52, 7
    s_add_u32 s73, s73, 1449984
    s_add_u32 s74, s93, 2048
    v_bfe_u32 v2, v0, 4, 1
    v_lshlrev_b32 v2, 5, v2
    v_xor_b32 v124, v2, v1
    v_xor_b32 v125, 64, v124
    s_lshl_b32 s48, s5, 13
    s_lshl_b32 s87, s4, 16
    s_add_u32 s87, s87, s48
    s_add_u32 s87, s87, 20971520
    s_lshl_b32 s88, s3, 11
    s_add_u32 s86, s48, 8192
    v_bfe_u32 v2, v0, 1, 1
    v_bfe_u32 v3, v0, 3, 1
    v_lshl_add_u32 v2, v3, 1, v2
    v_xor_b32 v2, 1, v2
    v_lshlrev_b32 v2, 5, v2
    v_lshl_add_u32 v2, v0, 7, v2
    v_add_u32 v28, s86, v2
    v_xor_b32 v29, 64, v28
    v_lshrrev_b32 v2, 4, v0
    v_lshlrev_b32 v3, 10, v2
    v_bfe_u32 v4, v0, 2, 2
    v_lshl_add_u32 v3, v4, 7, v3
    v_bfe_u32 v4, v0, 3, 2
    v_lshl_add_u32 v3, v4, 5, v3
    v_xor_b32 v27, 96, v3
    v_and_b32 v4, 3, v0
    v_lshl_add_u32 v24, v4, 3, v3
    v_xor_b32 v25, 64, v24
    v_and_b32 v4, 2, v0
    v_lshlrev_b32 v4, 5, v4
    v_xor_b32 v4, 32, v4
    v_xor_b32 v26, v4, v24
    s_waitcnt lgkmcnt(0)
    s_add_u32 s40, s40, 1
    s_mul_i32 s6, s40, 2654435761
    s_xor_b32 s6, s6, s41
    s_xor_b32 s6, s6, 1540483477
    s_mul_i32 s7, s40, 2246822507
    s_add_u32 s7, s7, s41
    s_xor_b32 s7, s7, 668265263
    v_mov_b32 v21, 0
    v_mov_b32 v22, s6
    v_mov_b32 v23, s7
    s_cmp_lg_u32 s5, 0
    s_cbranch_scc1 L_g2
    s_waitcnt vmcnt(2)
    s_call_b64 s[46:47], L_gemv
    s_waitcnt vmcnt(2)
    s_branch L_g3
L_g2:
    s_waitcnt vmcnt(0)
L_g3:
    buffer_load_dwordx4 v[48:51], v1, s[36:39], s90 offen sc1
    v_and_b32 v13, 4294901760, v8
    v_lshlrev_b32 v12, 16, v8
    v_and_b32 v15, 4294901760, v9
    v_lshlrev_b32 v14, 16, v9
    v_and_b32 v17, 4294901760, v10
    v_lshlrev_b32 v16, 16, v10
    v_and_b32 v19, 4294901760, v11
    v_lshlrev_b32 v18, 16, v11
    s_xor_b32 s92, s91, 0
    s_add_u32 m0, s93, 0
    s_nop 0
    buffer_load_dwordx4 v120, s[12:15], s92 offen lds
    s_add_u32 m0, s93, 1024
    s_nop 0
    buffer_load_dwordx4 v121, s[12:15], s92 offen lds
    s_add_u32 s92, s92, 16384
    s_add_u32 m0, s93, 2048
    s_nop 0
    buffer_load_dwordx4 v120, s[12:15], s92 offen lds
    s_add_u32 m0, s93, 3072
    s_nop 0
    buffer_load_dwordx4 v121, s[12:15], s92 offen lds
    v_dot2_f32_bf16 v64, v68, s97, 0
    v_dot2_f32_bf16 v65, v68, v68, 0
    v_dot2_f32_bf16 v64, v69, s97, v64
    v_dot2_f32_bf16 v65, v69, v69, v65
    v_dot2_f32_bf16 v64, v70, s97, v64
    v_dot2_f32_bf16 v65, v70, v70, v65
    v_dot2_f32_bf16 v64, v71, s97, v64
    v_dot2_f32_bf16 v65, v71, v71, v65
    s_nop 2
    v_permlane32_swap_b32 v64, v65
    v_add_f32 v64, v64, v65
    v_mov_b32 v65, v64
    s_nop 1
    v_permlane16_swap_b32 v64, v65
    v_add_f32 v64, v64, v65
    s_nop 1
    v_add_f32_dpp v65, v64, v64 row_ror:1 row_mask:0xf bank_mask:0xf
    s_nop 1
    v_add_f32_dpp v64, v65, v65 row_ror:2 row_mask:0xf bank_mask:0xf
    s_nop 1
    v_add_f32_dpp v65, v64, v64 row_ror:4 row_mask:0xf bank_mask:0xf
    s_nop 1
    v_add_f32_dpp v64, v65, v65 row_ror:8 row_mask:0xf bank_mask:0xf
    v_mul_f32 v64, 0.001953125, v64
    v_mov_b32 v65, s6
    v_readlane_b32 s48, v64, 32
    v_mov_b32 v67, s7
    s_lshr_b32 s49, s43, 6
    s_add_u32 s49, s49, 1474560
    v_fma_f32 v66, -v64, v64, s48
    v_max_f32 v66, 0, v66
    v_add_f32 v66, 1e-05, v66
    v_rsq_f32 v66, v66
    s_mov_b64 exec, 1
    buffer_store_dwordx4 v[64:67], v1, s[36:39], s49 offen sc1
    s_mov_b64 exec, -1
    s_cmp_lg_u32 s96, 0
    s_cbranch_scc1 L_pt_1
    s_waitcnt vmcnt(5)
    v_mov_b32 v32, v48
    v_mov_b32 v33, v49
    v_mov_b32 v34, v50
    v_mov_b32 v35, v51
    s_call_b64 s[46:47], L_try
L_pt_1:
    s_lshr_b32 s97, s91, 15
    s_lshl_b32 s97, s97, 9
    s_add_u32 s97, s97, 1474560
    v_and_b32 v31, 240, v1
    s_waitcnt vmcnt(2)
    ds_read_b128 v[128:131], v122
    ds_read_b128 v[132:135], v123
    s_cmp_lg_u32 s96, 0
    s_cbranch_scc1 L_nopoll_2
    buffer_load_dwordx4 v[40:43], v1, s[36:39], s90 offen sc1
L_nopoll_2:
    s_xor_b32 s92, s91, 128
    s_add_u32 m0, s93, 4096
    s_nop 0
    buffer_load_dwordx4 v120, s[12:15], s92 offen lds
    s_add_u32 m0, s93, 5120
    s_nop 0
    buffer_load_dwordx4 v121, s[12:15], s92 offen lds
    s_add_u32 s92, s92, 16384
    s_add_u32 m0, s93, 6144
    s_nop 0
    buffer_load_dwordx4 v120, s[12:15], s92 offen lds
    s_add_u32 m0, s93, 7168
    s_nop 0
    buffer_load_dwordx4 v121, s[12:15], s92 offen lds
    s_waitcnt vmcnt(4)
    ds_read_b128 v[192:195], v122 offset:2048
    ds_read_b128 v[196:199], v123 offset:2048
    s_waitcnt lgkmcnt(2)
    s_xor_b32 s92, s91, 256
    s_add_u32 m0, s93, 8192
    s_nop 0
    buffer_load_dwordx4 v120, s[12:15], s92 offen lds
    s_add_u32 m0, s93, 9216
    s_nop 0
    buffer_load_dwordx4 v121, s[12:15], s92 offen lds
    s_add_u32 s92, s92, 16384
    s_add_u32 m0, s93, 0
    s_nop 0
    buffer_load_dwordx4 v120, s[12:15], s92 offen lds
    s_add_u32 m0, s93, 1024
    s_nop 0
    buffer_load_dwordx4 v121, s[12:15], s92 offen lds
    s_waitcnt vmcnt(6)
    ds_read_b128 v[136:139], v122 offset:4096
    ds_read_b128 v[140:143], v123 offset:4096
    s_cmp_lg_u32 s96, 0
    s_cbranch_scc1 L_pub_3
    v_mov_b32 v32, v40
    v_mov_b32 v33, v41
    v_mov_b32 v34, v42
    v_mov_b32 v35, v43
    s_call_b64 s[46:47], L_try
L_pub_3:
    s_waitcnt lgkmcnt(2)
    s_cmp_lg_u32 s96, 0
    s_cbranch_scc1 L_nopoll_4
    buffer_load_dwordx4 v[44:47], v1, s[36:39], s90 offen sc1
L_nopoll_4:
    s_xor_b32 s92, s91, 384
    s_add_u32 m0, s93, 2048
    s_nop 0
    buffer_load_dwordx4 v120, s[12:15], s92 offen lds
    s_add_u32 m0, s93, 3072
    s_nop 0
    buffer_load_dwordx4 v121, s[12:15], s92 offen lds
    s_waitcnt vmcnt(6)
    ds_read_b128 v[200:203], v122 offset:6144
    ds_read_b128 v[204:207], v123 offset:6144
    s_waitcnt lgkmcnt(2)
    s_add_u32 s92, s92, 16384
    s_add_u32 m0, s93, 4096
    s_nop 0
    buffer_load_dwordx4 v120, s[12:15], s92 offen lds
    s_add_u32 m0, s93, 5120
    s_nop 0
    buffer_load_dwordx4 v121, s[12:15], s92 offen lds
    s_mov_b32 s10, 65535
    s_mov_b32 s11, 65535
    s_lshl_b32 s48, s4, 6
    s_add_u32 s48, s48, s5
    s_lshl_b32 s64, s48, 4
    s_add_u32 s64, s64, 1507328
    s_lshl_b32 s65, s48, 11
    s_add_u32 s65, s65, 2097152
    s_lshl_b32 s48, s3, 7
    s_add_u32 s66, s64, s48
    s_lshl_b32 s48, s3, 14
    s_add_u32 s67, s65, s48
    s_lshl_b32 s68, s5, 10
    s_waitcnt vmcnt(6)
    ds_read_b128 v[144:147], v122 offset:8192
    ds_read_b128 v[148:151], v123 offset:8192
    s_waitcnt lgkmcnt(2)
    s_cmp_lg_u32 s96, 0
    s_cbranch_scc1 L_nopoll_5
    buffer_load_dwordx4 v[48:51], v1, s[36:39], s90 offen sc1
L_nopoll_5:
    s_xor_b32 s92, s91, 512
    s_add_u32 m0, s93, 6144
    s_nop 0
    buffer_load_dwordx4 v120, s[12:15], s92 offen lds
    s_add_u32 m0, s93, 7168
    s_nop 0
    buffer_load_dwordx4 v121, s[12:15], s92 offen lds
    s_waitcnt vmcnt(6)
    ds_read_b128 v[208:211], v122
    ds_read_b128 v[212:215], v123
    s_waitcnt lgkmcnt(2)
    s_add_u32 s92, s92, 16384
    s_add_u32 m0, s93, 8192
    s_nop 0
    buffer_load_dwordx4 v120, s[12:15], s92 offen lds
    s_add_u32 m0, s93, 9216
    s_nop 0
    buffer_load_dwordx4 v121, s[12:15], s92 offen lds
    s_cmp_eq_u32 s75, 2
    s_cbranch_scc1 L_qwo
    v_lshrrev_b32 v126, 3, v0
    v_mul_u32_u24 v126, 3584, v126
    s_cmp_eq_u32 s75, 0
    s_cbranch_scc1 L_qw1
    v_lshrrev_b32 v126, 5, v0
    v_lshlrev_b32 v126, 13, v126
    v_bfe_u32 v2, v0, 3, 2
    v_lshl_add_u32 v126, v2, 10, v126
L_qw1:
    v_and_b32 v2, 112, v1
    v_add_u32 v126, v126, v2
    v_bfe_u32 v2, v0, 2, 2
    v_lshlrev_b32 v127, 7, v2
    v_bfe_u32 v2, v0, 4, 1
    v_lshl_add_u32 v127, v2, 5, v127
    s_movk_i32 s75, 64
L_qdone:
    v_lshrrev_b32 v2, 5, v0
    v_lshl_add_u32 v127, v2, 10, v127
    v_and_b32 v2, 3, v0
    v_lshl_add_u32 v127, v2, 3, v127
    v_add_u32 v127, s74, v127
    s_waitcnt vmcnt(6)
    ds_read_b128 v[152:155], v122 offset:2048
    ds_read_b128 v[156:159], v123 offset:2048
    s_cmp_lg_u32 s96, 0
    s_cbranch_scc1 L_pub_6
    v_mov_b32 v32, v44
    v_mov_b32 v33, v45
    v_mov_b32 v34, v46
    v_mov_b32 v35, v47
    s_call_b64 s[46:47], L_try
L_pub_6:
    s_waitcnt lgkmcnt(2)
    s_xor_b32 s92, s91, 640
    s_add_u32 m0, s93, 0
    s_nop 0
    buffer_load_dwordx4 v120, s[12:15], s92 offen lds
    s_add_u32 m0, s93, 1024
    s_nop 0
    buffer_load_dwordx4 v121, s[12:15], s92 offen lds
    s_waitcnt vmcnt(6)
    ds_read_b128 v[216:219], v122 offset:4096
    ds_read_b128 v[220:223], v123 offset:4096
    s_waitcnt lgkmcnt(2)
    s_add_u32 s92, s92, 16384
    s_add_u32 m0, s93, 2048
    s_nop 0
    buffer_load_dwordx4 v120, s[12:15], s92 offen lds
    s_add_u32 m0, s93, 3072
    s_nop 0
    buffer_load_dwordx4 v121, s[12:15], s92 offen lds
    s_waitcnt vmcnt(6)
    ds_read_b128 v[160:163], v122 offset:6144
    ds_read_b128 v[164:167], v123 offset:6144
    s_cmp_lg_u32 s96, 0
    s_cbranch_scc1 L_pub_7
    v_mov_b32 v32, v48
    v_mov_b32 v33, v49
    v_mov_b32 v34, v50
    v_mov_b32 v35, v51
    s_call_b64 s[46:47], L_try
L_pub_7:
    s_cmp_eq_u32 s96, 0
    s_cbranch_scc1 L_publ_9
L_pubd_8:
    s_waitcnt lgkmcnt(2)
    s_xor_b32 s92, s91, 768
    s_add_u32 m0, s93, 4096
    s_nop 0
    buffer_load_dwordx4 v120, s[12:15], s92 offen lds
    s_add_u32 m0, s93, 5120
    s_nop 0
    buffer_load_dwordx4 v121, s[12:15], s92 offen lds
    s_waitcnt vmcnt(6)
    ds_read_b128 v[224:227], v122 offset:8192
    ds_read_b128 v[228:231], v123 offset:8192
    s_waitcnt lgkmcnt(2)
    s_add_u32 s92, s92, 16384
    s_add_u32 m0, s93, 6144
    s_nop 0
    buffer_load_dwordx4 v120, s[12:15], s92 offen lds
    s_add_u32 m0, s93, 7168
    s_nop 0
    buffer_load_dwordx4 v121, s[12:15], s92 offen lds
    s_add_u32 s50, s88, 0
    s_and_b32 s50, s50, 7168
    s_add_u32 m0, s86, s50
    s_add_u32 s50, s50, s87
    buffer_load_dwordx4 v124, s[36:39], s50 offen sc1 lds
    s_add_u32 s50, s88, 1024
    s_and_b32 s50, s50, 7168
    s_add_u32 m0, s86, s50
    s_add_u32 s50, s50, s87
    buffer_load_dwordx4 v125, s[36:39], s50 offen sc1 lds
    s_add_u32 s50, s88, 2048
    s_and_b32 s50, s50, 7168
    s_add_u32 m0, s86, s50
    s_add_u32 s50, s50, s87
    buffer_load_dwordx4 v124, s[36:39], s50 offen sc1 lds
    s_add_u32 s50, s88, 3072
    s_and_b32 s50, s50, 7168
    s_add_u32 m0, s86, s50
    s_add_u32 s50, s50, s87
    buffer_load_dwordx4 v125, s[36:39], s50 offen sc1 lds
    s_add_u32 s50, s88, 4096
    s_and_b32 s50, s50, 7168
    s_add_u32 m0, s86, s50
    s_add_u32 s50, s50, s87
    buffer_load_dwordx4 v124, s[36:39], s50 offen sc1 lds
    s_add_u32 s50, s88, 5120
    s_and_b32 s50, s50, 7168
    s_add_u32 m0, s86, s50
    s_add_u32 s50, s50, s87
    buffer_load_dwordx4 v125, s[36:39], s50 offen sc1 lds
    s_add_u32 s50, s88, 6144
    s_and_b32 s50, s50, 7168
    s_add_u32 m0, s86, s50
    s_add_u32 s50, s50, s87
    buffer_load_dwordx4 v124, s[36:39], s50 offen sc1 lds
    s_add_u32 s50, s88, 7168
    s_and_b32 s50, s50, 7168
    s_add_u32 m0, s86, s50
    s_add_u32 s50, s50, s87
    buffer_load_dwordx4 v125, s[36:39], s50 offen sc1 lds
    buffer_load_dwordx4 v[112:115], v31, s[36:39], s97 offen offset:0 sc1
    buffer_load_dwordx4 v[116:119], v31, s[36:39], s97 offen offset:256 sc1
    s_waitcnt vmcnt(16)
    ds_read_b128 v[168:171], v122
    ds_read_b128 v[172:175], v123
    s_waitcnt lgkmcnt(2)
    s_xor_b32 s92, s91, 896
    s_add_u32 m0, s93, 8192
    s_nop 0
    buffer_load_dwordx4 v120, s[12:15], s92 offen lds
    s_add_u32 m0, s93, 9216
    s_nop 0
    buffer_load_dwordx4 v121, s[12:15], s92 offen lds
    v_and_b32 v12, 7, v0
    v_mul_u32_u24 v12, 384, v12
    v_lshrrev_b32 v13, 3, v0
    s_mul_i32 s48, s5, 12
    v_add_u32 v13, s48, v13
    v_lshl_add_u32 v12, v13, 2, v12
    v_and_b32 v2, 3, v13
    v_lshrrev_b32 v13, 2, v13
    v_lshlrev_b32 v13, 11, v13
    v_lshl_add_u32 v13, v2, 2, v13
    v_lshrrev_b32 v14, 4, v0
    s_add_u32 s48, s68, 73728
    v_lshrrev_b32 v16, 2, v31
    v_add_u32 v16, s48, v16
    v_lshlrev_b32 v17, 4, v14
    v_add_u32 v17, s48, v17
    v_lshlrev_b32 v14, 11, v14
    v_bfe_u32 v15, v0, 2, 2
    v_lshlrev_b32 v15, 11, v15
    v_and_b32 v2, 3, v0
    v_lshl_add_u32 v15, v2, 2, v15
    v_add_u32 v20, s68, v1
    v_add_u32 v21, 73728, v20
    v_and_b32 v6, 240, v1
    v_lshrrev_b32 v2, 5, v0
    v_lshl_add_u32 v6, v2, 8, v6
    v_add_u32 v6, 73728, v6
    v_and_b32 v2, 7, v0
    v_xor_b32 v2, s3, v2
    v_lshlrev_b32 v30, 7, v2
    v_and_b32 v2, 8, v0
    v_lshl_add_u32 v18, v2, 3, v30
    v_add_u32 v19, s75, v127
    s_waitcnt vmcnt(16)
    ds_read_b128 v[232:235], v122 offset:2048
    ds_read_b128 v[236:239], v123 offset:2048
    s_waitcnt lgkmcnt(2)
    s_add_u32 s92, s92, 16384
    s_add_u32 m0, s93, 0
    s_nop 0
    buffer_load_dwordx4 v120, s[12:15], s92 offen lds
    s_add_u32 m0, s93, 1024
    s_nop 0
    buffer_load_dwordx4 v121, s[12:15], s92 offen lds
    s_waitcnt vmcnt(4)
    ds_read_b64 v[40:41], v28 offset:24
    ds_read_b64 v[42:43], v29 offset:8
L_wpchk:
    s_waitcnt lgkmcnt(0)
    v_cmp_ne_u64 vcc, s[6:7], v[40:41]
    v_cmp_ne_u64 s[54:55], s[6:7], v[42:43]
    s_nop 0
    s_or_b64 s[54:55], vcc, s[54:55]
    s_cbranch_scc1 L_wpretry
L_wpok:
    s_lshl_b32 s48, s5, 13
    v_add_u32 v2, s48, v27
    v_add_u32 v3, s48, v24
    v_add_u32 v4, s48, v25
    v_add_u32 v5, s48, v26
    s_lshl_b32 s48, s94, 13
    v_add_u32 v24, s48, v24
    v_add_u32 v25, s48, v25
    v_add_u32 v26, s48, v26
    ds_read_b64_tr_b16 v[32:33], v2 offset:8192
    ds_read_b64_tr_b16 v[34:35], v2 offset:8704
    ds_read_b64_tr_b16 v[36:37], v3 offset:8192
    ds_read_b64_tr_b16 v[38:39], v3 offset:8704
    ds_read_b64_tr_b16 v[40:41], v4 offset:8192
    ds_read_b64_tr_b16 v[42:43], v4 offset:8704
    ds_read_b64_tr_b16 v[44:45], v5 offset:8192
    ds_read_b64_tr_b16 v[46:47], v5 offset:8704
    ds_read_b64_tr_b16 v[48:49], v2 offset:12288
    ds_read_b64_tr_b16 v[50:51], v2 offset:12800
    ds_read_b64_tr_b16 v[52:53], v3 offset:12288
    ds_read_b64_tr_b16 v[54:55], v3 offset:12800
    ds_read_b64_tr_b16 v[56:57], v4 offset:12288
    ds_read_b64_tr_b16 v[58:59], v4 offset:12800
    s_waitcnt lgkmcnt(12)
    ds_read_b64_tr_b16 v[60:61], v5 offset:12288
    ds_read_b64_tr_b16 v[62:63], v5 offset:12800
    v_and_b32 v2, 1, v0
    v_lshlrev_b32 v2, 6, v2
    v_lshrrev_b32 v3, 4, v0
    v_lshl_add_u32 v2, v3, 4, v2
    s_mul_i32 s48, s5, 384
    v_add_u32 v2, s48, v2
    s_mov_b32 s54, 196611
    s_mov_b32 s55, 196611
    s_waitcnt lgkmcnt(12)
    v_mfma_f32_16x16x32_bf16 v[64:67], v[36:39], v[32:35], 0
    s_waitcnt lgkmcnt(10)
    v_mfma_f32_16x16x32_bf16 v[68:71], v[40:43], v[32:35], 0
    s_waitcnt lgkmcnt(8)
    v_mfma_f32_16x16x32_bf16 v[72:75], v[44:47], v[32:35], 0
    s_waitcnt lgkmcnt(4)
    v_mfma_f32_16x16x32_bf16 v[64:67], v[52:55], v[48:51], v[64:67]
    s_waitcnt lgkmcnt(2)
    v_mfma_f32_16x16x32_bf16 v[68:71], v[56:59], v[48:51], v[68:71]
    s_waitcnt lgkmcnt(0)
    v_mfma_f32_16x16x32_bf16 v[72:75], v[60:63], v[48:51], v[72:75]
    s_mov_b64 exec, s[54:55]
    s_nop 2
    ds_write_b128 v2, v[64:67]
    s_nop 0
    ds_write_b128 v2, v[68:71] offset:128
    s_nop 0
    ds_write_b128 v2, v[72:75] offset:256
    s_mov_b64 exec, -1
L_chk_18:
    v_cmp_ne_u32 vcc, s6, v113
    v_cmp_ne_u32 s[50:51], s7, v115
    v_cmp_ne_u32 s[52:53], s6, v117
    v_cmp_ne_u32 s[54:55], s7, v119
    s_or_b64 vcc, vcc, s[50:51]
    s_or_b64 s[52:53], s[52:53], s[54:55]
    s_or_b64 vcc, vcc, s[52:53]
    s_cbranch_scc1 L_rty_19
L_ok_20:
    ds_write_b32 v16, v114
    ds_write_b32 v16, v112 offset:128
    ds_write_b32 v16, v118 offset:64
    ds_write_b32 v16, v116 offset:192
    s_waitcnt lgkmcnt(0)
    ds_read_b128 v[88:91], v17
    ds_read_b128 v[96:99], v17 offset:128
    ds_read_b128 v[92:95], v17 offset:64
    ds_read_b128 v[100:103], v17 offset:192
    s_barrier
    ds_read_b64_tr_b16 v[32:33], v25 offset:8192
    ds_read_b64_tr_b16 v[34:35], v25 offset:8704
    ds_read_b64_tr_b16 v[36:37], v26 offset:8192
    ds_read_b64_tr_b16 v[38:39], v26 offset:8704
    ds_read_b64_tr_b16 v[40:41], v25 offset:12288
    ds_read_b64_tr_b16 v[42:43], v25 offset:12800
    ds_read_b64_tr_b16 v[44:45], v26 offset:12288
    ds_read_b64_tr_b16 v[46:47], v26 offset:12800
    s_add_u32 m0, s74, 0
    s_nop 0
    buffer_load_dwordx4 v126, s[20:23], s69 offen nt lds
    s_waitcnt lgkmcnt(6)
    v_mfma_f32_16x16x32_bf16 v[64:67], v[32:35], v[128:131], 0
    v_xor_b32 v25, 8192, v25
    ds_read_b64_tr_b16 v[48:49], v25 offset:8192
    ds_read_b32 v104, v12
    v_mfma_f32_16x16x32_bf16 v[68:71], v[32:35], v[192:195], 0
    ds_read_b64_tr_b16 v[50:51], v25 offset:8704
    ds_read_b32 v105, v12 offset:32
    s_add_u32 m0, s74, 1024
    s_add_u32 s69, s69, s70
    buffer_load_dwordx4 v126, s[20:23], s69 offen nt lds
    s_waitcnt lgkmcnt(8)
    v_mfma_f32_16x16x32_bf16 v[72:75], v[128:131], v[36:39], 0
    v_xor_b32 v26, 8192, v26
    ds_read_b64_tr_b16 v[52:53], v26 offset:8192
    v_mfma_f32_16x16x32_bf16 v[76:79], v[192:195], v[36:39], 0
    ds_read_b64_tr_b16 v[54:55], v26 offset:8704
    s_waitcnt lgkmcnt(8)
    v_mfma_f32_16x16x32_bf16 v[64:67], v[40:43], v[132:135], v[64:67]
    ds_read_b64_tr_b16 v[56:57], v25 offset:12288
    v_mfma_f32_16x16x32_bf16 v[68:71], v[40:43], v[196:199], v[68:71]
    ds_read_b64_tr_b16 v[58:59], v25 offset:12800
    s_waitcnt lgkmcnt(8)
    v_mfma_f32_16x16x32_bf16 v[72:75], v[132:135], v[44:47], v[72:75]
    ds_read_b64_tr_b16 v[60:61], v26 offset:12288
    v_mfma_f32_16x16x32_bf16 v[76:79], v[196:199], v[44:47], v[76:79]
    ds_read_b64_tr_b16 v[62:63], v26 offset:12800
    s_waitcnt lgkmcnt(7)
    v_mfma_f32_16x16x32_bf16 v[64:67], v[48:51], v[136:139], v[64:67]
    v_xor_b32 v25, 24576, v25
    ds_read_b64_tr_b16 v[32:33], v25 offset:8192
    s_waitcnt lgkmcnt(7)
    v_mfma_f32_16x16x32_bf16 v[68:71], v[48:51], v[200:203], v[68:71]
    ds_read_b64_tr_b16 v[34:35], v25 offset:8704
    v_add_f32_dpp v106, v104, v104 quad_perm:[1,0,3,2] row_mask:0xf bank_mask:0xf
    s_waitcnt lgkmcnt(6)
    v_mfma_f32_16x16x32_bf16 v[72:75], v[136:139], v[52:55], v[72:75]
    v_xor_b32 v26, 24576, v26
    ds_read_b64_tr_b16 v[36:37], v26 offset:8192
    v_add_f32_dpp v107, v105, v105 quad_perm:[1,0,3,2] row_mask:0xf bank_mask:0xf
    v_mfma_f32_16x16x32_bf16 v[76:79], v[200:203], v[52:55], v[76:79]
    ds_read_b64_tr_b16 v[38:39], v26 offset:8704
    v_add_f32_dpp v104, v106, v106 quad_perm:[2,3,0,1] row_mask:0xf bank_mask:0xf
    s_waitcnt lgkmcnt(6)
    v_mfma_f32_16x16x32_bf16 v[64:67], v[56:59], v[140:143], v[64:67]
    ds_read_b64_tr_b16 v[40:41], v25 offset:12288
    v_add_f32_dpp v105, v107, v107 quad_perm:[2,3,0,1] row_mask:0xf bank_mask:0xf
    v_mfma_f32_16x16x32_bf16 v[68:71], v[56:59], v[204:207], v[68:71]
    ds_read_b64_tr_b16 v[42:43], v25 offset:12800
    v_add_f32_dpp v106, v104, v104 row_half_mirror row_mask:0xf bank_mask:0xf
    s_waitcnt lgkmcnt(6)
    v_mfma_f32_16x16x32_bf16 v[72:75], v[140:143], v[60:63], v[72:75]
    ds_read_b64_tr_b16 v[44:45], v26 offset:12288
    v_add_f32_dpp v107, v105, v105 row_half_mirror row_mask:0xf bank_mask:0xf
    v_mfma_f32_16x16x32_bf16 v[76:79], v[204:207], v[60:63], v[76:79]
    ds_read_b64_tr_b16 v[46:47], v26 offset:12800
    ds_write_b32 v13, v106 offset:8240
    s_waitcnt lgkmcnt(7)
    v_mfma_f32_16x16x32_bf16 v[64:67], v[32:35], v[144:147], v[64:67]
    v_xor_b32 v25, 8192, v25
    ds_read_b64_tr_b16 v[48:49], v25 offset:8192
    ds_write_b32 v13, v107 offset:12336
    v_mfma_f32_16x16x32_bf16 v[68:71], v[32:35], v[208:211], v[68:71]
    ds_read_b64_tr_b16 v[50:51], v25 offset:8704
    s_waitcnt lgkmcnt(8)
    v_mfma_f32_16x16x32_bf16 v[72:75], v[144:147], v[36:39], v[72:75]
    v_xor_b32 v26, 8192, v26
    ds_read_b64_tr_b16 v[52:53], v26 offset:8192
    v_mfma_f32_16x16x32_bf16 v[76:79], v[208:211], v[36:39], v[76:79]
    ds_read_b64_tr_b16 v[54:55], v26 offset:8704
    s_waitcnt lgkmcnt(8)
    v_mfma_f32_16x16x32_bf16 v[64:67], v[40:43], v[148:151], v[64:67]
    ds_read_b64_tr_b16 v[56:57], v25 offset:12288
    v_mfma_f32_16x16x32_bf16 v[68:71], v[40:43], v[212:215], v[68:71]
    ds_read_b64_tr_b16 v[58:59], v25 offset:12800
    s_waitcnt lgkmcnt(8)
    v_mfma_f32_16x16x32_bf16 v[72:75], v[148:151], v[44:47], v[72:75]
    ds_read_b64_tr_b16 v[60:61], v26 offset:12288
    v_mfma_f32_16x16x32_bf16 v[76:79], v[212:215], v[44:47], v[76:79]
    ds_read_b64_tr_b16 v[62:63], v26 offset:12800
    s_waitcnt lgkmcnt(6)
    v_mfma_f32_16x16x32_bf16 v[64:67], v[48:51], v[152:155], v[64:67]
    v_xor_b32 v25, 57344, v25
    ds_read_b64_tr_b16 v[32:33], v25 offset:8192
    v_mfma_f32_16x16x32_bf16 v[68:71], v[48:51], v[216:219], v[68:71]
    ds_read_b64_tr_b16 v[34:35], v25 offset:8704
    s_waitcnt lgkmcnt(6)
    v_mfma_f32_16x16x32_bf16 v[72:75], v[152:155], v[52:55], v[72:75]
    v_xor_b32 v26, 57344, v26
    ds_read_b64_tr_b16 v[36:37], v26 offset:8192
    v_mfma_f32_16x16x32_bf16 v[76:79], v[216:219], v[52:55], v[76:79]
    ds_read_b64_tr_b16 v[38:39], v26 offset:8704
    s_waitcnt lgkmcnt(6)
    v_mfma_f32_16x16x32_bf16 v[64:67], v[56:59], v[156:159], v[64:67]
    ds_read_b64_tr_b16 v[40:41], v25 offset:12288
    v_mfma_f32_16x16x32_bf16 v[68:71], v[56:59], v[220:223], v[68:71]
    ds_read_b64_tr_b16 v[42:43], v25 offset:12800
    s_waitcnt lgkmcnt(6)
    v_mfma_f32_16x16x32_bf16 v[72:75], v[156:159], v[60:63], v[72:75]
    ds_read_b64_tr_b16 v[44:45], v26 offset:12288
    v_mfma_f32_16x16x32_bf16 v[76:79], v[220:223], v[60:63], v[76:79]
    ds_read_b64_tr_b16 v[46:47], v26 offset:12800
    s_waitcnt lgkmcnt(6)
    v_mfma_f32_16x16x32_bf16 v[64:67], v[32:35], v[160:163], v[64:67]
    v_xor_b32 v25, 8192, v25
    ds_read_b64_tr_b16 v[48:49], v25 offset:8192
    v_mfma_f32_16x16x32_bf16 v[68:71], v[32:35], v[224:227], v[68:71]
    ds_read_b64_tr_b16 v[50:51], v25 offset:8704
    s_barrier
    s_waitcnt lgkmcnt(6)
    v_mfma_f32_16x16x32_bf16 v[72:75], v[160:163], v[36:39], v[72:75]
    v_xor_b32 v26, 8192, v26
    ds_read_b64_tr_b16 v[52:53], v26 offset:8192
    ds_read_b128 v[104:107], v14 offset:32816
    v_mfma_f32_16x16x32_bf16 v[76:79], v[224:227], v[36:39], v[76:79]
    ds_read_b64_tr_b16 v[54:55], v26 offset:8704
    ds_read_b128 v[108:111], v14 offset:24624
    s_setprio 3
    s_waitcnt lgkmcnt(8)
    v_mfma_f32_16x16x32_bf16 v[64:67], v[40:43], v[164:167], v[64:67]
    ds_read_b64_tr_b16 v[56:57], v25 offset:12288
    ds_read_b32 v113, v15 offset:49200
    v_mfma_f32_16x16x32_bf16 v[68:71], v[40:43], v[228:231], v[68:71]
    ds_read_b64_tr_b16 v[58:59], v25 offset:12800
    ds_read_b32 v115, v15 offset:41008
    s_waitcnt lgkmcnt(10)
    v_mfma_f32_16x16x32_bf16 v[72:75], v[164:167], v[44:47], v[72:75]
    ds_read_b64_tr_b16 v[60:61], v26 offset:12288
    ds_read_b128 v[8:11], v14 offset:16432
    v_mfma_f32_16x16x32_bf16 v[76:79], v[228:231], v[44:47], v[76:79]
    ds_read_b64_tr_b16 v[62:63], v26 offset:12800
    ds_read_b128 v[28:31], v14 offset:8240
    ds_read_b128 v[176:179], v122 offset:4096
    ds_read_b128 v[180:183], v123 offset:4096
    s_waitcnt lgkmcnt(14)
    v_mfma_f32_16x16x32_bf16 v[64:67], v[48:51], v[168:171], v[64:67]
    v_xor_b32 v25, 24576, v25
    ds_read_b64_tr_b16 v[32:33], v25 offset:8192
    v_mov_b32 v4, v18
    v_mfma_f32_16x16x32_bf16 v[68:71], v[48:51], v[232:235], v[68:71]
    ds_read_b64_tr_b16 v[34:35], v25 offset:8704
    v_mov_b32 v5, v19
    ds_read_b128 v[240:243], v122 offset:6144
    ds_read_b128 v[244:247], v123 offset:6144
    s_waitcnt lgkmcnt(15)
    v_mfma_f32_16x16x32_bf16 v[72:75], v[168:171], v[52:55], v[72:75]
    v_xor_b32 v26, 24576, v26
    ds_read_b64_tr_b16 v[36:37], v26 offset:8192
    v_mov_b32 v3, v6
    v_mfma_f32_16x16x32_bf16 v[76:79], v[232:235], v[52:55], v[76:79]
    ds_read_b64_tr_b16 v[38:39], v26 offset:8704
    s_waitcnt lgkmcnt(13)
    v_mfma_f32_16x16x32_bf16 v[64:67], v[56:59], v[172:175], v[64:67]
    ds_read_b64_tr_b16 v[40:41], v25 offset:12288
    v_mfma_f32_16x16x32_bf16 v[68:71], v[56:59], v[236:239], v[68:71]
    ds_read_b64_tr_b16 v[42:43], v25 offset:12800
    s_waitcnt lgkmcnt(11)
    v_mfma_f32_16x16x32_bf16 v[72:75], v[172:175], v[60:63], v[72:75]
    ds_read_b64_tr_b16 v[44:45], v26 offset:12288
    v_mfma_f32_16x16x32_bf16 v[76:79], v[236:239], v[60:63], v[76:79]
    ds_read_b64_tr_b16 v[46:47], v26 offset:12800
    s_waitcnt vmcnt(4)
    ds_read_b128 v[184:187], v122 offset:8192
    ds_read_b128 v[188:191], v123 offset:8192
    s_waitcnt lgkmcnt(10)
    s_waitcnt lgkmcnt(8)
    v_mfma_f32_16x16x32_bf16 v[64:67], v[32:35], v[176:179], v[64:67]
    v_xor_b32 v25, 8192, v25
    ds_read_b64_tr_b16 v[48:49], v25 offset:8192
    v_mfma_f32_16x16x32_bf16 v[68:71], v[32:35], v[240:243], v[68:71]
    ds_read_b64_tr_b16 v[50:51], v25 offset:8704
    s_waitcnt vmcnt(2)
    ds_read_b128 v[248:251], v122
    ds_read_b128 v[252:255], v123
    s_waitcnt lgkmcnt(10)
    v_mfma_f32_16x16x32_bf16 v[72:75], v[176:179], v[36:39], v[72:75]
    v_xor_b32 v26, 8192, v26
    ds_read_b64_tr_b16 v[52:53], v26 offset:8192
    v_mfma_f32_16x16x32_bf16 v[76:79], v[240:243], v[36:39], v[76:79]
    ds_read_b64_tr_b16 v[54:55], v26 offset:8704
    s_waitcnt lgkmcnt(10)
    v_mfma_f32_16x16x32_bf16 v[64:67], v[40:43], v[180:183], v[64:67]
    ds_read_b64_tr_b16 v[56:57], v25 offset:12288
    v_mfma_f32_16x16x32_bf16 v[68:71], v[40:43], v[244:247], v[68:71]
    ds_read_b64_tr_b16 v[58:59], v25 offset:12800
    s_waitcnt lgkmcnt(10)
    v_mfma_f32_16x16x32_bf16 v[72:75], v[180:183], v[44:47], v[72:75]
    ds_read_b64_tr_b16 v[60:61], v26 offset:12288
    v_mfma_f32_16x16x32_bf16 v[76:79], v[244:247], v[44:47], v[76:79]
    ds_read_b64_tr_b16 v[62:63], v26 offset:12800
    s_setprio 2
    s_waitcnt lgkmcnt(8)
    s_waitcnt lgkmcnt(6)
    v_mfma_f32_16x16x32_bf16 v[64:67], v[48:51], v[184:187], v[64:67]
    ds_read_b64_tr_b16 v[32:33], v24 offset:8192
    v_mfma_f32_16x16x32_bf16 v[68:71], v[48:51], v[248:251], v[68:71]
    ds_read_b64_tr_b16 v[34:35], v24 offset:8704
    s_waitcnt lgkmcnt(6)
    v_mfma_f32_16x16x32_bf16 v[72:75], v[184:187], v[52:55], v[72:75]
    ds_read_b64_tr_b16 v[36:37], v24 offset:12288
    v_mfma_f32_16x16x32_bf16 v[76:79], v[248:251], v[52:55], v[76:79]
    ds_read_b64_tr_b16 v[38:39], v24 offset:12800
    s_waitcnt lgkmcnt(6)
    v_mfma_f32_16x16x32_bf16 v[64:67], v[56:59], v[188:191], v[64:67]
    v_xor_b32 v24, 8192, v24
    ds_read_b64_tr_b16 v[40:41], v24 offset:8192
    v_mfma_f32_16x16x32_bf16 v[68:71], v[56:59], v[252:255], v[68:71]
    ds_read_b64_tr_b16 v[42:43], v24 offset:8704
    s_waitcnt lgkmcnt(6)
    v_mfma_f32_16x16x32_bf16 v[72:75], v[188:191], v[60:63], v[72:75]
    ds_read_b64_tr_b16 v[44:45], v24 offset:12288
    v_mfma_f32_16x16x32_bf16 v[76:79], v[252:255], v[60:63], v[76:79]
    ds_read_b64_tr_b16 v[46:47], v24 offset:12800
    s_waitcnt lgkmcnt(6)
    v_mfma_f32_16x16x32_bf16 v[80:83], v[32:35], v[128:131], 0
    v_xor_b32 v24, 24576, v24
    ds_read_b64_tr_b16 v[48:49], v24 offset:8192
    v_mfma_f32_16x16x32_bf16 v[84:87], v[32:35], v[192:195], 0
    ds_read_b64_tr_b16 v[50:51], v24 offset:8704
    v_fma_f32 v64, -v112, v104, v64
    v_fma_f32 v65, -v112, v105, v65
    s_waitcnt lgkmcnt(6)
    v_mfma_f32_16x16x32_bf16 v[80:83], v[36:39], v[132:135], v[80:83]
    ds_read_b64_tr_b16 v[52:53], v24 offset:12288
    v_fma_f32 v66, -v112, v106, v66
    v_fma_f32 v67, -v112, v107, v67
    v_fma_f32 v64, v64, v114, v108
    v_mfma_f32_16x16x32_bf16 v[84:87], v[36:39], v[196:199], v[84:87]
    ds_read_b64_tr_b16 v[54:55], v24 offset:12800
    v_fma_f32 v65, v65, v114, v109
    v_fma_f32 v66, v66, v114, v110
    v_fma_f32 v67, v67, v114, v111
    s_waitcnt lgkmcnt(6)
    v_mfma_f32_16x16x32_bf16 v[80:83], v[40:43], v[136:139], v[80:83]
    v_xor_b32 v24, 8192, v24
    ds_read_b64_tr_b16 v[56:57], v24 offset:8192
    v_cvt_pk_bf16_f32 v12, v64, v65
    v_cvt_pk_bf16_f32 v13, v66, v67
    v_fma_f32 v68, -v116, v104, v68
    v_mfma_f32_16x16x32_bf16 v[84:87], v[40:43], v[200:203], v[84:87]
    ds_read_b64_tr_b16 v[58:59], v24 offset:8704
    v_fma_f32 v69, -v116, v105, v69
    v_fma_f32 v70, -v116, v106, v70
    v_fma_f32 v71, -v116, v107, v71
    s_waitcnt lgkmcnt(6)
    v_mfma_f32_16x16x32_bf16 v[80:83], v[44:47], v[140:143], v[80:83]
    ds_read_b64_tr_b16 v[60:61], v24 offset:12288
    v_fma_f32 v68, v68, v118, v108
    v_fma_f32 v69, v69, v118, v109
    v_fma_f32 v70, v70, v118, v110
    v_mfma_f32_16x16x32_bf16 v[84:87], v[44:47], v[204:207], v[84:87]
    ds_read_b64_tr_b16 v[62:63], v24 offset:12800
    v_fma_f32 v71, v71, v118, v111
    v_cvt_pk_bf16_f32 v14, v68, v69
    v_cvt_pk_bf16_f32 v15, v70, v71
    s_setprio 1
    s_waitcnt lgkmcnt(6)
    v_mfma_f32_16x16x32_bf16 v[80:83], v[48:51], v[144:147], v[80:83]
    v_xor_b32 v24, 57344, v24
    ds_read_b64_tr_b16 v[32:33], v24 offset:8192
    v_fma_f32 v72, -v96, v113, v72
    v_fma_f32 v73, -v97, v113, v73
    v_fma_f32 v74, -v98, v113, v74
    v_mfma_f32_16x16x32_bf16 v[84:87], v[48:51], v[208:211], v[84:87]
    ds_read_b64_tr_b16 v[34:35], v24 offset:8704
    v_fma_f32 v75, -v99, v113, v75
    v_permlane16_swap_b32 v12, v14
    v_permlane16_swap_b32 v13, v15
    s_waitcnt lgkmcnt(6)
    v_mfma_f32_16x16x32_bf16 v[80:83], v[52:55], v[148:151], v[80:83]
    ds_read_b64_tr_b16 v[36:37], v24 offset:12288
    buffer_store_dwordx4 v[12:15], v1, s[36:39], s67 offen sc1
    ds_write_b128 v20, v[12:15]
    v_fma_f32 v76, -v100, v113, v76
    v_mfma_f32_16x16x32_bf16 v[84:87], v[52:55], v[212:215], v[84:87]
    ds_read_b64_tr_b16 v[38:39], v24 offset:12800
    v_fma_f32 v77, -v101, v113, v77
    v_fma_f32 v78, -v102, v113, v78
    v_fma_f32 v79, -v103, v113, v79
    s_waitcnt lgkmcnt(7)
    v_mfma_f32_16x16x32_bf16 v[80:83], v[56:59], v[152:155], v[80:83]
    v_xor_b32 v24, 8192, v24
    ds_read_b64_tr_b16 v[40:41], v24 offset:8192
    v_fma_f32 v72, v72, v88, v115
    v_fma_f32 v73, v73, v89, v115
    v_fma_f32 v74, v74, v90, v115
    v_mfma_f32_16x16x32_bf16 v[84:87], v[56:59], v[216:219], v[84:87]
    ds_read_b64_tr_b16 v[42:43], v24 offset:8704
    v_fma_f32 v75, v75, v91, v115
    v_fma_f32 v76, v76, v92, v115
    v_fma_f32 v77, v77, v93, v115
    s_waitcnt lgkmcnt(7)
    v_mfma_f32_16x16x32_bf16 v[80:83], v[60:63], v[156:159], v[80:83]
    ds_read_b64_tr_b16 v[44:45], v24 offset:12288
    v_fma_f32 v78, v78, v94, v115
    v_fma_f32 v79, v79, v95, v115
    v_cvt_pk_bf16_f32 v16, v72, v73
    v_mfma_f32_16x16x32_bf16 v[84:87], v[60:63], v[220:223], v[84:87]
    ds_read_b64_tr_b16 v[46:47], v24 offset:12800
    v_cvt_pk_bf16_f32 v17, v74, v75
    v_cvt_pk_bf16_f32 v18, v76, v77
    v_cvt_pk_bf16_f32 v19, v78, v79
    s_waitcnt lgkmcnt(7)
    v_mfma_f32_16x16x32_bf16 v[80:83], v[32:35], v[160:163], v[80:83]
    v_xor_b32 v24, 24576, v24
    ds_read_b64_tr_b16 v[48:49], v24 offset:8192
    v_mul_f32 v114, 0.36067376022224085, v114
    v_mul_f32 v118, 0.36067376022224085, v118
    v_permlane32_swap_b32 v16, v18
    v_mfma_f32_16x16x32_bf16 v[84:87], v[32:35], v[224:227], v[84:87]
    ds_read_b64_tr_b16 v[50:51], v24 offset:8704
    v_permlane32_swap_b32 v17, v19
    buffer_store_dwordx4 v[16:19], v1, s[36:39], s67 offen offset:1024 sc1
    ds_write_b128 v21, v[16:19]
    s_waitcnt lgkmcnt(7)
    v_mfma_f32_16x16x32_bf16 v[80:83], v[36:39], v[164:167], v[80:83]
    ds_read_b64_tr_b16 v[52:53], v24 offset:12288
    v_mul_f32 v28, 0.36067376022224085, v28
    v_mul_f32 v29, 0.36067376022224085, v29
    v_mul_f32 v30, 0.36067376022224085, v30
    v_mfma_f32_16x16x32_bf16 v[84:87], v[36:39], v[228:231], v[84:87]
    ds_read_b64_tr_b16 v[54:55], v24 offset:12800
    v_mul_f32 v31, 0.36067376022224085, v31
    s_waitcnt vmcnt(2)
    ds_read_b64_tr_b16 v[128:129], v127
    s_waitcnt lgkmcnt(8)
    v_mfma_f32_16x16x32_bf16 v[80:83], v[40:43], v[168:171], v[80:83]
    v_xor_b32 v24, 8192, v24
    ds_read_b64_tr_b16 v[56:57], v24 offset:8192
    ds_read_b64_tr_b16 v[130:131], v127 offset:512
    ds_read_b64_tr_b16 v[132:133], v5
    ds_read_b64_tr_b16 v[134:135], v5 offset:512
    v_mfma_f32_16x16x32_bf16 v[84:87], v[40:43], v[232:235], v[84:87]
    ds_read_b64_tr_b16 v[58:59], v24 offset:8704
    s_waitcnt lgkmcnt(11)
    v_mfma_f32_16x16x32_bf16 v[80:83], v[44:47], v[172:175], v[80:83]
    ds_read_b64_tr_b16 v[60:61], v24 offset:12288
    v_mfma_f32_16x16x32_bf16 v[84:87], v[44:47], v[236:239], v[84:87]
    ds_read_b64_tr_b16 v[62:63], v24 offset:12800
    s_setprio 0
    s_waitcnt lgkmcnt(11)
    v_mfma_f32_16x16x32_bf16 v[80:83], v[48:51], v[176:179], v[80:83]
    v_mfma_f32_16x16x32_bf16 v[84:87], v[48:51], v[240:243], v[84:87]
    s_waitcnt lgkmcnt(8)
    v_mfma_f32_16x16x32_bf16 v[80:83], v[52:55], v[180:183], v[80:83]
    v_mfma_f32_16x16x32_bf16 v[84:87], v[52:55], v[244:247], v[84:87]
    s_waitcnt lgkmcnt(2)
    v_mfma_f32_16x16x32_bf16 v[80:83], v[56:59], v[184:187], v[80:83]
    v_mfma_f32_16x16x32_bf16 v[84:87], v[56:59], v[248:251], v[84:87]
    s_waitcnt lgkmcnt(0)
    v_mfma_f32_16x16x32_bf16 v[80:83], v[60:63], v[188:191], v[80:83]
    v_mfma_f32_16x16x32_bf16 v[84:87], v[60:63], v[252:255], v[84:87]
    s_waitcnt lgkmcnt(0)
    s_mov_b32 s54, 1114112
    s_mov_b32 s55, 1114112
    v_mov_b32 v17, 1065369472
    v_cndmask_b32 v16, 0, v17, s[54:55]
    v_mov_b32 v17, v16
    v_mov_b32 v18, v16
    v_mov_b32 v19, v16
    v_fma_f32 v80, -v112, v8, v80
    v_fma_f32 v81, -v112, v9, v81
    v_fma_f32 v82, -v112, v10, v82
    v_fma_f32 v83, -v112, v11, v83
    v_fma_f32 v80, v80, v114, v28
    v_fma_f32 v81, v81, v114, v29
    v_fma_f32 v82, v82, v114, v30
    v_fma_f32 v83, v83, v114, v31
    v_fma_f32 v84, -v116, v8, v84
    v_fma_f32 v85, -v116, v9, v85
    v_fma_f32 v86, -v116, v10, v86
    v_fma_f32 v87, -v116, v11, v87
    v_fma_f32 v84, v84, v118, v28
    v_fma_f32 v85, v85, v118, v29
    v_fma_f32 v86, v86, v118, v30
    v_fma_f32 v87, v87, v118, v31
    s_barrier
    ds_read_b128 v[12:15], v1
    v_cvt_pk_bf16_f32 v8, v80, v81
    v_cvt_pk_bf16_f32 v9, v82, v83
    v_cvt_pk_bf16_f32 v10, v84, v85
    v_cvt_pk_bf16_f32 v11, v86, v87
    v_mov_b32 v72, v22
    v_mov_b32 v73, v23
    v_mov_b32 v20, v16
    v_mov_b32 v21, v16
    v_mov_b32 v22, v16
    v_mov_b32 v23, v16
    v_permlane16_swap_b32 v8, v10
    v_permlane16_swap_b32 v9, v11
    s_setprio 3
    s_waitcnt vmcnt(0)
    s_mov_b64 exec, 1
    buffer_store_dwordx2 v[72:73], v1, s[36:39], s66 offen sc1
    s_mov_b64 exec, -1
    s_sub_u32 s48, s5, 5
    s_cmp_lt_u32 s48, 2
    s_cbranch_scc1 L_w12_21
L_w12d_22:
    s_waitcnt lgkmcnt(0)
    v_mfma_f32_32x32x16_bf16 v[40:55], v[12:15], v[8:11], 0
    ds_read_b128 v[12:15], v1 offset:1024
    s_nop 10
    v_exp_f32 v40, v40
    v_exp_f32 v41, v41
    s_mov_b64 exec, s[10:11]
    ds_read_b128 v[16:19], v3
    ds_read_b128 v[20:23], v3 offset:512
    s_mov_b64 exec, -1
    v_exp_f32 v42, v42
    v_cvt_pk_bf16_f32 v40, v40, v41
    v_exp_f32 v43, v43
    v_exp_f32 v44, v44
    v_cvt_pk_bf16_f32 v41, v42, v43
    v_exp_f32 v45, v45
    s_waitcnt lgkmcnt(2)
    v_mfma_f32_32x32x16_bf16 v[56:71], v[12:15], v[8:11], 0
    ds_read_b128 v[12:15], v1 offset:2048
    v_exp_f32 v46, v46
    v_cvt_pk_bf16_f32 v42, v44, v45
    v_exp_f32 v47, v47
    v_exp_f32 v48, v48
    v_cvt_pk_bf16_f32 v43, v46, v47
    v_exp_f32 v49, v49
    v_exp_f32 v50, v50
    s_waitcnt lgkmcnt(1)
    v_mfma_f32_32x32x16_bf16 v[24:39], v[16:19], v[40:43], 0
    s_and_b32 s84, s1, 3
    s_and_b32 s85, s1, 7
    s_lshr_b32 s86, s63, 2
    s_lshr_b32 s87, s63, 3
    s_mul_i32 s81, s85, 7
    s_add_u32 s81, s81, s5
    s_lshl_b32 s76, s81, 2
    s_and_b32 s48, s87, 0
    s_add_u32 s76, s76, s48
    s_lshl_b32 s76, s76, 13
    s_add_u32 s76, s76, 23068672
    s_lshr_b32 s81, s81, 1
    s_lshl_b32 s81, s81, 5
    buffer_store_dwordx4 v[128:131], v1, s[36:39], s71 offen sc1
    buffer_store_dwordx4 v[132:135], v1, s[36:39], s72 offen sc1
    v_cvt_pk_bf16_f32 v48, v48, v49
    v_exp_f32 v51, v51
    v_exp_f32 v52, v52
    v_cvt_pk_bf16_f32 v49, v50, v51
    v_exp_f32 v53, v53
    v_exp_f32 v54, v54
    v_exp_f32 v55, v55
    v_cvt_pk_bf16_f32 v50, v52, v53
    v_cvt_pk_bf16_f32 v51, v54, v55
    v_exp_f32 v56, v56
    v_exp_f32 v57, v57
    v_mfma_f32_32x32x16_bf16 v[24:39], v[20:23], v[48:51], v[24:39]
    s_mov_b64 exec, s[10:11]
    ds_read_b128 v[16:19], v3 offset:1024
    ds_read_b128 v[20:23], v3 offset:1536
    s_mov_b64 exec, -1
    v_exp_f32 v58, v58
    v_cvt_pk_bf16_f32 v56, v56, v57
    v_exp_f32 v59, v59
    v_exp_f32 v60, v60
    v_cvt_pk_bf16_f32 v57, v58, v59
    v_exp_f32 v61, v61
    s_waitcnt lgkmcnt(2)
    v_mfma_f32_32x32x16_bf16 v[40:55], v[12:15], v[8:11], 0
    ds_read_b128 v[12:15], v1 offset:3072
    v_exp_f32 v62, v62
    v_cvt_pk_bf16_f32 v58, v60, v61
    v_exp_f32 v63, v63
    v_exp_f32 v64, v64
    v_cvt_pk_bf16_f32 v59, v62, v63
    v_exp_f32 v65, v65
    v_exp_f32 v66, v66
    s_waitcnt lgkmcnt(1)
    v_mfma_f32_32x32x16_bf16 v[24:39], v[16:19], v[56:59], v[24:39]
    v_cvt_pk_bf16_f32 v64, v64, v65
    v_exp_f32 v67, v67
    v_exp_f32 v68, v68
    v_cvt_pk_bf16_f32 v65, v66, v67
    v_exp_f32 v69, v69
    v_exp_f32 v70, v70
    v_exp_f32 v71, v71
    v_cvt_pk_bf16_f32 v66, v68, v69
    v_cvt_pk_bf16_f32 v67, v70, v71
    v_exp_f32 v40, v40
    v_exp_f32 v41, v41
    v_mfma_f32_32x32x16_bf16 v[24:39], v[20:23], v[64:67], v[24:39]
    s_mov_b64 exec, s[10:11]
    ds_read_b128 v[16:19], v3 offset:2048
    ds_read_b128 v[20:23], v3 offset:2560
    s_mov_b64 exec, -1
    v_exp_f32 v42, v42
    v_cvt_pk_bf16_f32 v40, v40, v41
    v_exp_f32 v43, v43
    v_exp_f32 v44, v44
    v_cvt_pk_bf16_f32 v41, v42, v43
    v_exp_f32 v45, v45
    s_waitcnt lgkmcnt(2)
    v_mfma_f32_32x32x16_bf16 v[56:71], v[12:15], v[8:11], 0
    ds_read_b128 v[12:15], v1 offset:4096
    v_exp_f32 v46, v46
    v_cvt_pk_bf16_f32 v42, v44, v45
    v_exp_f32 v47, v47
    v_exp_f32 v48, v48
    v_cvt_pk_bf16_f32 v43, v46, v47
    v_exp_f32 v49, v49
    v_exp_f32 v50, v50
    s_waitcnt lgkmcnt(1)
    v_mfma_f32_32x32x16_bf16 v[24:39], v[16:19], v[40:43], v[24:39]
    s_lshl_b32 s82, s84, 3
    s_add_u32 s82, s82, s5
    s_lshl_b32 s80, s82, 5
    s_add_u32 s43, s86, s84
    s_and_b32 s43, s43, 3
    s_lshl_b32 s77, s82, 2
    s_add_u32 s77, s77, s43
    s_lshl_b32 s77, s77, 12
    s_add_u32 s77, s77, 27262976
    s_lshr_b32 s82, s82, 1
    s_lshl_b32 s82, s82, 4
    s_add_u32 s82, s82, 1760
    s_add_u32 s19, s5, s85
    s_and_b32 s19, s19, 7
    s_mul_i32 s83, s19, 112
    s_add_u32 s83, s83, s85
    s_add_u32 s83, s83, 896
    v_cvt_pk_bf16_f32 v48, v48, v49
    v_exp_f32 v51, v51
    v_exp_f32 v52, v52
    v_cvt_pk_bf16_f32 v49, v50, v51
    v_exp_f32 v53, v53
    v_exp_f32 v54, v54
    v_exp_f32 v55, v55
    v_cvt_pk_bf16_f32 v50, v52, v53
    v_cvt_pk_bf16_f32 v51, v54, v55
    s_setprio 2
    v_exp_f32 v56, v56
    v_exp_f32 v57, v57
    v_mfma_f32_32x32x16_bf16 v[24:39], v[20:23], v[48:51], v[24:39]
    s_mov_b64 exec, s[10:11]
    ds_read_b128 v[16:19], v3 offset:3072
    ds_read_b128 v[20:23], v3 offset:3584
    s_mov_b64 exec, -1
    v_exp_f32 v58, v58
    v_cvt_pk_bf16_f32 v56, v56, v57
    v_exp_f32 v59, v59
    v_exp_f32 v60, v60
    v_cvt_pk_bf16_f32 v57, v58, v59
    v_exp_f32 v61, v61
    s_waitcnt lgkmcnt(2)
    v_mfma_f32_32x32x16_bf16 v[40:55], v[12:15], v[8:11], 0
    ds_read_b128 v[12:15], v1 offset:5120
    v_exp_f32 v62, v62
    v_cvt_pk_bf16_f32 v58, v60, v61
    v_exp_f32 v63, v63
    v_exp_f32 v64, v64
    v_cvt_pk_bf16_f32 v59, v62, v63
    v_exp_f32 v65, v65
    v_exp_f32 v66, v66
    s_waitcnt lgkmcnt(1)
    v_mfma_f32_32x32x16_bf16 v[24:39], v[16:19], v[56:59], v[24:39]
    s_cmp_ge_u32 s5, 4
    s_cbranch_scc1 L_ld_23
    buffer_load_dwordx2 v[124:125], v4, s[36:39], s64 offen sc1
L_ld_23:
    s_lshl_b32 s48, s3, 3
    s_add_u32 s48, s48, s5
    s_lshl_b32 s48, s48, 5
    s_add_u32 s48, s48, s4
    s_lshl_b32 s16, s48, 10
    s_add_u32 s16, s16, 6291456
    s_lshl_b32 s48, s63, 3
    s_add_u32 s48, s48, s5
    s_lshl_b32 s69, s48, 10
    s_add_u32 s70, s69, 10485760
    s_add_u32 s69, s69, 8388608
    s_lshl_b32 s71, s48, 8
    s_add_u32 s71, s71, 12582912
    v_cvt_pk_bf16_f32 v64, v64, v65
    v_exp_f32 v67, v67
    v_exp_f32 v68, v68
    v_cvt_pk_bf16_f32 v65, v66, v67
    v_exp_f32 v69, v69
    v_exp_f32 v70, v70
    v_exp_f32 v71, v71
    v_cvt_pk_bf16_f32 v66, v68, v69
    v_cvt_pk_bf16_f32 v67, v70, v71
    s_setprio 1
    v_exp_f32 v40, v40
    v_exp_f32 v41, v41
    v_mfma_f32_32x32x16_bf16 v[24:39], v[20:23], v[64:67], v[24:39]
    s_mov_b64 exec, s[10:11]
    ds_read_b128 v[16:19], v3 offset:4096
    ds_read_b128 v[20:23], v3 offset:4608
    s_mov_b64 exec, -1
    v_exp_f32 v42, v42
    v_cvt_pk_bf16_f32 v40, v40, v41
    v_exp_f32 v43, v43
    v_exp_f32 v44, v44
    v_cvt_pk_bf16_f32 v41, v42, v43
    v_exp_f32 v45, v45
    s_waitcnt lgkmcnt(2)
    v_mfma_f32_32x32x16_bf16 v[56:71], v[12:15], v[8:11], 0
    ds_read_b128 v[12:15], v1 offset:6144
    v_exp_f32 v46, v46
    v_cvt_pk_bf16_f32 v42, v44, v45
    v_exp_f32 v47, v47
    v_exp_f32 v48, v48
    v_cvt_pk_bf16_f32 v43, v46, v47
    v_exp_f32 v49, v49
    v_exp_f32 v50, v50
    s_waitcnt lgkmcnt(1)
    v_mfma_f32_32x32x16_bf16 v[24:39], v[16:19], v[40:43], v[24:39]
    s_lshl_b32 s79, s85, 18
    s_lshl_b32 s52, s19, 15
    s_add_u32 s79, s79, s52
    s_add_u32 s79, s79, 25165824
    s_cmp_eq_u32 s5, 7
    s_cselect_b32 s76, s79, s76
    s_mul_i32 s88, s5, 6144
    s_cmp_ge_u32 s5, 5
    s_cselect_b32 s48, 34816, 0
    s_add_u32 s88, s88, s48
    s_add_u32 s88, s88, 73728
    s_lshl_b32 s89, s5, 12
    s_mov_b32 s78, 1449984
    s_mul_i32 s72, s63, 28672
    s_lshl_b32 s48, s5, 11
    s_add_u32 s72, s72, s48
    s_add_u32 s72, s72, 13631488
    s_add_u32 s73, s72, 14336
    v_cvt_pk_bf16_f32 v48, v48, v49
    v_exp_f32 v51, v51
    v_exp_f32 v52, v52
    v_cvt_pk_bf16_f32 v49, v50, v51
    v_exp_f32 v53, v53
    v_exp_f32 v54, v54
    v_exp_f32 v55, v55
    v_cvt_pk_bf16_f32 v50, v52, v53
    v_cvt_pk_bf16_f32 v51, v54, v55
    s_setprio 0
    v_exp_f32 v56, v56
    v_exp_f32 v57, v57
    v_mfma_f32_32x32x16_bf16 v[24:39], v[20:23], v[48:51], v[24:39]
    s_mov_b64 exec, s[10:11]
    ds_read_b128 v[16:19], v3 offset:5120
    ds_read_b128 v[20:23], v3 offset:5632
    s_mov_b64 exec, -1
    v_exp_f32 v58, v58
    v_cvt_pk_bf16_f32 v56, v56, v57
    v_exp_f32 v59, v59
    v_exp_f32 v60, v60
    v_cvt_pk_bf16_f32 v57, v58, v59
    v_exp_f32 v61, v61
    s_waitcnt lgkmcnt(2)
    v_mfma_f32_32x32x16_bf16 v[40:55], v[12:15], v[8:11], 0
    ds_read_b128 v[12:15], v1 offset:7168
    v_exp_f32 v62, v62
    v_cvt_pk_bf16_f32 v58, v60, v61
    v_exp_f32 v63, v63
    v_exp_f32 v64, v64
    v_cvt_pk_bf16_f32 v59, v62, v63
    v_exp_f32 v65, v65
    v_exp_f32 v66, v66
    s_waitcnt lgkmcnt(1)
    v_mfma_f32_32x32x16_bf16 v[24:39], v[16:19], v[56:59], v[24:39]
    s_cmp_ge_u32 s5, 4
    s_cbranch_scc1 L_ld_24
    s_waitcnt vmcnt(0)
L_chk_25:
    v_cmp_ne_u64 vcc, s[6:7], v[124:125]
    s_nop 0
    s_and_b32 vcc_lo, vcc_lo, 514
    s_cbranch_scc1 L_rty_26
L_ok_27:
    s_xor_b32 s48, s3, 1
    s_lshl_b32 s48, s48, 14
    s_add_u32 s48, s48, s65
    s_add_u32 m0, s68, 8192
    s_nop 0
    buffer_load_dwordx4 v1, s[36:39], s48 offen sc1 lds
    s_add_u32 m0, s68, 80896
    s_nop 0
    buffer_load_dwordx4 v1, s[36:39], s48 offen offset:1024 sc1 lds
    s_add_u32 s48, s48, 8192
    s_add_u32 m0, s68, 12288
    s_nop 0
    buffer_load_dwordx4 v1, s[36:39], s48 offen sc1 lds
    s_add_u32 m0, s68, 84992
    s_nop 0
    buffer_load_dwordx4 v1, s[36:39], s48 offen offset:1024 sc1 lds
    buffer_load_dwordx2 v[124:125], v4, s[36:39], s64 offen sc1
L_ld_24:
    v_cvt_pk_bf16_f32 v64, v64, v65
    v_exp_f32 v67, v67
    v_exp_f32 v68, v68
    v_cvt_pk_bf16_f32 v65, v66, v67
    v_exp_f32 v69, v69
    v_exp_f32 v70, v70
    v_exp_f32 v71, v71
    v_cvt_pk_bf16_f32 v66, v68, v69
    v_cvt_pk_bf16_f32 v67, v70, v71
    s_waitcnt vmcnt(0)
    s_sub_u32 s48, s5, 5
    s_cmp_lt_u32 s48, 2
    s_cbranch_scc1 L_w12_28
L_w12d_29:
    s_waitcnt vmcnt(1)
    s_waitcnt lgkmcnt(0)
    s_barrier
    s_cmp_eq_u32 s5, 3
    s_cbranch_scc1 L_pf_30
L_pfd_31:
    s_setprio 3
    v_exp_f32 v40, v40
    v_exp_f32 v41, v41
    v_mfma_f32_32x32x16_bf16 v[24:39], v[20:23], v[64:67], v[24:39]
    s_mov_b64 exec, s[10:11]
    ds_read_b128 v[16:19], v3 offset:6144
    ds_read_b128 v[20:23], v3 offset:6656
    s_mov_b64 exec, -1
    v_exp_f32 v42, v42
    v_cvt_pk_bf16_f32 v40, v40, v41
    v_exp_f32 v43, v43
    v_exp_f32 v44, v44
    v_cvt_pk_bf16_f32 v41, v42, v43
    v_exp_f32 v45, v45
    v_mfma_f32_32x32x16_bf16 v[56:71], v[12:15], v[8:11], 0
    ds_read_b128 v[12:15], v1 offset:8192
    v_exp_f32 v46, v46
    v_cvt_pk_bf16_f32 v42, v44, v45
    v_exp_f32 v47, v47
    v_exp_f32 v48, v48
    v_cvt_pk_bf16_f32 v43, v46, v47
    v_exp_f32 v49, v49
    v_exp_f32 v50, v50
    s_waitcnt lgkmcnt(1)
    v_mfma_f32_32x32x16_bf16 v[24:39], v[16:19], v[40:43], v[24:39]
    s_cmp_ge_u32 s5, 4
    s_cbranch_scc1 L_ld_32
    s_waitcnt vmcnt(0)
L_chk_33:
    v_cmp_ne_u64 vcc, s[6:7], v[124:125]
    s_nop 0
    s_and_b32 vcc_lo, vcc_lo, 1028
    s_cbranch_scc1 L_rty_34
L_ok_35:
    s_xor_b32 s48, s3, 2
    s_lshl_b32 s48, s48, 14
    s_add_u32 s48, s48, s65
    s_add_u32 m0, s68, 16384
    s_nop 0
    buffer_load_dwordx4 v1, s[36:39], s48 offen sc1 lds
    s_add_u32 m0, s68, 89088
    s_nop 0
    buffer_load_dwordx4 v1, s[36:39], s48 offen offset:1024 sc1 lds
    s_add_u32 s48, s48, 8192
    s_add_u32 m0, s68, 20480
    s_nop 0
    buffer_load_dwordx4 v1, s[36:39], s48 offen sc1 lds
    s_add_u32 m0, s68, 93184
    s_nop 0
    buffer_load_dwordx4 v1, s[36:39], s48 offen offset:1024 sc1 lds
L_ld_32:
    v_cvt_pk_bf16_f32 v48, v48, v49
    v_exp_f32 v51, v51
    v_exp_f32 v52, v52
    v_cvt_pk_bf16_f32 v49, v50, v51
    v_exp_f32 v53, v53
    v_exp_f32 v54, v54
    v_exp_f32 v55, v55
    v_cvt_pk_bf16_f32 v50, v52, v53
    v_cvt_pk_bf16_f32 v51, v54, v55
    v_exp_f32 v56, v56
    v_exp_f32 v57, v57
    v_mfma_f32_32x32x16_bf16 v[24:39], v[20:23], v[48:51], v[24:39]
    s_mov_b64 exec, s[10:11]
    ds_read_b128 v[16:19], v3 offset:7168
    ds_read_b128 v[20:23], v3 offset:7680
    s_mov_b64 exec, -1
    v_exp_f32 v58, v58
    v_cvt_pk_bf16_f32 v56, v56, v57
    v_exp_f32 v59, v59
    v_exp_f32 v60, v60
    v_cvt_pk_bf16_f32 v57, v58, v59
    v_exp_f32 v61, v61
    s_waitcnt lgkmcnt(2)
    v_mfma_f32_32x32x16_bf16 v[40:55], v[12:15], v[8:11], 0
    ds_read_b128 v[12:15], v1 offset:9216
    v_exp_f32 v62, v62
    v_cvt_pk_bf16_f32 v58, v60, v61
    v_exp_f32 v63, v63
    v_exp_f32 v64, v64
    v_cvt_pk_bf16_f32 v59, v62, v63
    v_exp_f32 v65, v65
    v_exp_f32 v66, v66
    s_waitcnt lgkmcnt(1)
    v_mfma_f32_32x32x16_bf16 v[24:39], v[16:19], v[56:59], v[24:39]
    v_mov_b32 v128, -1
    v_mov_b32 v129, -1
    v_mov_b32 v130, -1
    v_mov_b32 v131, -1
    v_cvt_pk_bf16_f32 v64, v64, v65
    v_exp_f32 v67, v67
    v_exp_f32 v68, v68
    v_cvt_pk_bf16_f32 v65, v66, v67
    v_exp_f32 v69, v69
    v_exp_f32 v70, v70
    v_exp_f32 v71, v71
    v_cvt_pk_bf16_f32 v66, v68, v69
    v_cvt_pk_bf16_f32 v67, v70, v71
    v_exp_f32 v40, v40
    v_exp_f32 v41, v41
    v_mfma_f32_32x32x16_bf16 v[24:39], v[20:23], v[64:67], v[24:39]
    s_mov_b64 exec, s[10:11]
    ds_read_b128 v[16:19], v3 offset:8192
    ds_read_b128 v[20:23], v3 offset:8704
    s_mov_b64 exec, -1
    v_exp_f32 v42, v42
    v_cvt_pk_bf16_f32 v40, v40, v41
    v_exp_f32 v43, v43
    v_exp_f32 v44, v44
    v_cvt_pk_bf16_f32 v41, v42, v43
    v_exp_f32 v45, v45
    s_waitcnt lgkmcnt(2)
    v_mfma_f32_32x32x16_bf16 v[56:71], v[12:15], v[8:11], 0
    ds_read_b128 v[12:15], v1 offset:10240
    v_exp_f32 v46, v46
    v_cvt_pk_bf16_f32 v42, v44, v45
    v_exp_f32 v47, v47
    v_exp_f32 v48, v48
    v_cvt_pk_bf16_f32 v43, v46, v47
    v_exp_f32 v49, v49
    v_exp_f32 v50, v50
    s_waitcnt lgkmcnt(1)
    v_mfma_f32_32x32x16_bf16 v[24:39], v[16:19], v[40:43], v[24:39]
    s_cmp_ge_u32 s5, 4
    s_cbranch_scc1 L_ld_36
L_chk_37:
    v_cmp_ne_u64 vcc, s[6:7], v[124:125]
    s_nop 0
    s_and_b32 vcc_lo, vcc_lo, 2056
    s_cbranch_scc1 L_rty_38
L_ok_39:
    s_xor_b32 s48, s3, 3
    s_lshl_b32 s48, s48, 14
    s_add_u32 s48, s48, s65
    s_add_u32 m0, s68, 24576
    s_nop 0
    buffer_load_dwordx4 v1, s[36:39], s48 offen sc1 lds
    s_add_u32 m0, s68, 97280
    s_nop 0
    buffer_load_dwordx4 v1, s[36:39], s48 offen offset:1024 sc1 lds
    s_add_u32 s48, s48, 8192
    s_add_u32 m0, s68, 28672
    s_nop 0
    buffer_load_dwordx4 v1, s[36:39], s48 offen sc1 lds
    s_add_u32 m0, s68, 101376
    s_nop 0
    buffer_load_dwordx4 v1, s[36:39], s48 offen offset:1024 sc1 lds
    buffer_load_dwordx2 v[124:125], v4, s[36:39], s64 offen sc1
L_ld_36:
    buffer_store_dwordx4 v[128:131], v1, s[36:39], s16 offen offset:0 sc1
    v_cvt_pk_bf16_f32 v48, v48, v49
    v_exp_f32 v51, v51
    v_exp_f32 v52, v52
    v_cvt_pk_bf16_f32 v49, v50, v51
    v_exp_f32 v53, v53
    v_exp_f32 v54, v54
    v_exp_f32 v55, v55
    v_cvt_pk_bf16_f32 v50, v52, v53
    v_cvt_pk_bf16_f32 v51, v54, v55
    v_exp_f32 v56, v56
    v_exp_f32 v57, v57
    v_mfma_f32_32x32x16_bf16 v[24:39], v[20:23], v[48:51], v[24:39]
    s_mov_b64 exec, s[10:11]
    ds_read_b128 v[16:19], v3 offset:9216
    ds_read_b128 v[20:23], v3 offset:9728
    s_mov_b64 exec, -1
    v_exp_f32 v58, v58
    v_cvt_pk_bf16_f32 v56, v56, v57
    v_exp_f32 v59, v59
    v_exp_f32 v60, v60
    v_cvt_pk_bf16_f32 v57, v58, v59
    v_exp_f32 v61, v61
    s_waitcnt lgkmcnt(2)
    v_mfma_f32_32x32x16_bf16 v[40:55], v[12:15], v[8:11], 0
    ds_read_b128 v[12:15], v1 offset:11264
    v_exp_f32 v62, v62
    v_cvt_pk_bf16_f32 v58, v60, v61
    v_exp_f32 v63, v63
    v_exp_f32 v64, v64
    v_cvt_pk_bf16_f32 v59, v62, v63
    v_exp_f32 v65, v65
    v_exp_f32 v66, v66
    s_waitcnt lgkmcnt(1)
    v_mfma_f32_32x32x16_bf16 v[24:39], v[16:19], v[56:59], v[24:39]
    v_cvt_pk_bf16_f32 v64, v64, v65
    v_exp_f32 v67, v67
    v_exp_f32 v68, v68
    v_cvt_pk_bf16_f32 v65, v66, v67
    v_exp_f32 v69, v69
    v_exp_f32 v70, v70
    v_exp_f32 v71, v71
    v_cvt_pk_bf16_f32 v66, v68, v69
    v_cvt_pk_bf16_f32 v67, v70, v71
    s_setprio 2
    v_exp_f32 v40, v40
    v_exp_f32 v41, v41
    v_mfma_f32_32x32x16_bf16 v[24:39], v[20:23], v[64:67], v[24:39]
    s_mov_b64 exec, s[10:11]
    ds_read_b128 v[16:19], v3 offset:10240
    ds_read_b128 v[20:23], v3 offset:10752
    s_mov_b64 exec, -1
    v_exp_f32 v42, v42
    v_cvt_pk_bf16_f32 v40, v40, v41
    v_exp_f32 v43, v43
    v_exp_f32 v44, v44
    v_cvt_pk_bf16_f32 v41, v42, v43
    v_exp_f32 v45, v45
    s_waitcnt lgkmcnt(2)
    v_mfma_f32_32x32x16_bf16 v[56:71], v[12:15], v[8:11], 0
    ds_read_b128 v[12:15], v1 offset:12288
    v_exp_f32 v46, v46
    v_cvt_pk_bf16_f32 v42, v44, v45
    v_exp_f32 v47, v47
    v_exp_f32 v48, v48
    v_cvt_pk_bf16_f32 v43, v46, v47
    v_exp_f32 v49, v49
    v_exp_f32 v50, v50
    s_waitcnt lgkmcnt(1)
    v_mfma_f32_32x32x16_bf16 v[24:39], v[16:19], v[40:43], v[24:39]
    s_cmp_ge_u32 s5, 4
    s_cbranch_scc1 L_ld_40
    s_waitcnt vmcnt(1)
L_chk_41:
    v_cmp_ne_u64 vcc, s[6:7], v[124:125]
    s_nop 0
    s_and_b32 vcc_lo, vcc_lo, 4112
    s_cbranch_scc1 L_rty_42
L_ok_43:
    s_xor_b32 s48, s3, 4
    s_lshl_b32 s48, s48, 14
    s_add_u32 s48, s48, s65
    s_add_u32 m0, s68, 32768
    s_nop 0
    buffer_load_dwordx4 v1, s[36:39], s48 offen sc1 lds
    s_add_u32 m0, s68, 105472
    s_nop 0
    buffer_load_dwordx4 v1, s[36:39], s48 offen offset:1024 sc1 lds
    s_add_u32 s48, s48, 8192
    s_add_u32 m0, s68, 36864
    s_nop 0
    buffer_load_dwordx4 v1, s[36:39], s48 offen sc1 lds
    s_add_u32 m0, s68, 109568
    s_nop 0
    buffer_load_dwordx4 v1, s[36:39], s48 offen offset:1024 sc1 lds
L_ld_40:
    v_and_b32 v122, 496, v1
    v_cvt_pk_bf16_f32 v48, v48, v49
    v_exp_f32 v51, v51
    v_exp_f32 v52, v52
    v_cvt_pk_bf16_f32 v49, v50, v51
    v_exp_f32 v53, v53
    v_exp_f32 v54, v54
    v_exp_f32 v55, v55
    v_cvt_pk_bf16_f32 v50, v52, v53
    v_cvt_pk_bf16_f32 v51, v54, v55
    v_exp_f32 v56, v56
    v_exp_f32 v57, v57
    v_mfma_f32_32x32x16_bf16 v[24:39], v[20:23], v[48:51], v[24:39]
    s_mov_b64 exec, s[10:11]
    ds_read_b128 v[16:19], v3 offset:11264
    ds_read_b128 v[20:23], v3 offset:11776
    s_mov_b64 exec, -1
    v_exp_f32 v58, v58
    v_cvt_pk_bf16_f32 v56, v56, v57
    v_exp_f32 v59, v59
    v_exp_f32 v60, v60
    v_cvt_pk_bf16_f32 v57, v58, v59
    v_exp_f32 v61, v61
    s_waitcnt lgkmcnt(2)
    v_mfma_f32_32x32x16_bf16 v[40:55], v[12:15], v[8:11], 0
    ds_read_b128 v[12:15], v1 offset:13312
    v_exp_f32 v62, v62
    v_cvt_pk_bf16_f32 v58, v60, v61
    v_exp_f32 v63, v63
    v_exp_f32 v64, v64
    v_cvt_pk_bf16_f32 v59, v62, v63
    v_exp_f32 v65, v65
    v_exp_f32 v66, v66
    s_waitcnt lgkmcnt(1)
    v_mfma_f32_32x32x16_bf16 v[24:39], v[16:19], v[56:59], v[24:39]
    buffer_store_dwordx4 v[128:131], v1, s[36:39], s70 offen offset:0 sc1
    s_mov_b64 exec, 65535
    buffer_store_dwordx4 v[128:131], v1, s[36:39], s71 offen offset:0 sc1
    s_mov_b64 exec, -1
    v_cvt_pk_bf16_f32 v64, v64, v65
    v_exp_f32 v67, v67
    v_exp_f32 v68, v68
    v_cvt_pk_bf16_f32 v65, v66, v67
    v_exp_f32 v69, v69
    v_exp_f32 v70, v70
    v_exp_f32 v71, v71
    v_cvt_pk_bf16_f32 v66, v68, v69
    v_cvt_pk_bf16_f32 v67, v70, v71
    s_setprio 1
    v_exp_f32 v40, v40
    v_exp_f32 v41, v41
    v_mfma_f32_32x32x16_bf16 v[24:39], v[20:23], v[64:67], v[24:39]
    s_mov_b64 exec, s[10:11]
    ds_read_b128 v[16:19], v3 offset:12288
    ds_read_b128 v[20:23], v3 offset:12800
    s_mov_b64 exec, -1
    v_exp_f32 v42, v42
    v_cvt_pk_bf16_f32 v40, v40, v41
    v_exp_f32 v43, v43
    v_exp_f32 v44, v44
    v_cvt_pk_bf16_f32 v41, v42, v43
    v_exp_f32 v45, v45
    s_waitcnt lgkmcnt(2)
    v_mfma_f32_32x32x16_bf16 v[56:71], v[12:15], v[8:11], 0
    ds_read_b128 v[12:15], v1 offset:14336
    v_exp_f32 v46, v46
    v_cvt_pk_bf16_f32 v42, v44, v45
    v_exp_f32 v47, v47
    v_exp_f32 v48, v48
    v_cvt_pk_bf16_f32 v43, v46, v47
    v_exp_f32 v49, v49
    v_exp_f32 v50, v50
    s_waitcnt lgkmcnt(1)
    v_mfma_f32_32x32x16_bf16 v[24:39], v[16:19], v[40:43], v[24:39]
    v_cvt_pk_bf16_f32 v48, v48, v49
    v_exp_f32 v51, v51
    v_exp_f32 v52, v52
    v_cvt_pk_bf16_f32 v49, v50, v51
    v_exp_f32 v53, v53
    v_exp_f32 v54, v54
    v_exp_f32 v55, v55
    v_cvt_pk_bf16_f32 v50, v52, v53
    v_cvt_pk_bf16_f32 v51, v54, v55
    s_setprio 0
    v_exp_f32 v56, v56
    v_exp_f32 v57, v57
    v_mfma_f32_32x32x16_bf16 v[24:39], v[20:23], v[48:51], v[24:39]
    s_mov_b64 exec, s[10:11]
    ds_read_b128 v[16:19], v3 offset:13312
    ds_read_b128 v[20:23], v3 offset:13824
    s_mov_b64 exec, -1
    v_exp_f32 v58, v58
    v_cvt_pk_bf16_f32 v56, v56, v57
    v_exp_f32 v59, v59
    v_exp_f32 v60, v60
    v_cvt_pk_bf16_f32 v57, v58, v59
    v_exp_f32 v61, v61
    s_waitcnt lgkmcnt(2)
    v_mfma_f32_32x32x16_bf16 v[40:55], v[12:15], v[8:11], 0
    ds_read_b128 v[12:15], v1 offset:15360
    v_exp_f32 v62, v62
    v_cvt_pk_bf16_f32 v58, v60, v61
    v_exp_f32 v63, v63
    v_exp_f32 v64, v64
    v_cvt_pk_bf16_f32 v59, v62, v63
    v_exp_f32 v65, v65
    v_exp_f32 v66, v66
    s_waitcnt lgkmcnt(1)
    v_mfma_f32_32x32x16_bf16 v[24:39], v[16:19], v[56:59], v[24:39]
    s_sub_u32 s48, s5, 1
    s_cmp_lt_u32 s48, 2
    s_cbranch_scc1 L_w12_44
L_w12d_45:
    v_cvt_pk_bf16_f32 v64, v64, v65
    v_exp_f32 v67, v67
    v_exp_f32 v68, v68
    v_cvt_pk_bf16_f32 v65, v66, v67
    v_exp_f32 v69, v69
    v_exp_f32 v70, v70
    v_exp_f32 v71, v71
    v_cvt_pk_bf16_f32 v66, v68, v69
    v_cvt_pk_bf16_f32 v67, v70, v71
    s_waitcnt lgkmcnt(0)
    s_barrier
    s_setprio 3
    v_exp_f32 v40, v40
    v_exp_f32 v41, v41
    v_mfma_f32_32x32x16_bf16 v[24:39], v[20:23], v[64:67], v[24:39]
    s_mov_b64 exec, s[10:11]
    ds_read_b128 v[16:19], v3 offset:14336
    ds_read_b128 v[20:23], v3 offset:14848
    s_mov_b64 exec, -1
    v_exp_f32 v42, v42
    v_cvt_pk_bf16_f32 v40, v40, v41
    v_exp_f32 v43, v43
    v_exp_f32 v44, v44
    v_cvt_pk_bf16_f32 v41, v42, v43
    v_exp_f32 v45, v45
    v_mfma_f32_32x32x16_bf16 v[56:71], v[12:15], v[8:11], 0
    ds_read_b128 v[12:15], v1 offset:16384
    v_exp_f32 v46, v46
    v_cvt_pk_bf16_f32 v42, v44, v45
    v_exp_f32 v47, v47
    v_exp_f32 v48, v48
    v_cvt_pk_bf16_f32 v43, v46, v47
    v_exp_f32 v49, v49
    v_exp_f32 v50, v50
    s_waitcnt lgkmcnt(1)
    v_mfma_f32_32x32x16_bf16 v[24:39], v[16:19], v[40:43], v[24:39]
    s_cmp_ge_u32 s5, 4
    s_cbranch_scc1 L_ld_46
L_chk_47:
    v_cmp_ne_u64 vcc, s[6:7], v[124:125]
    s_nop 0
    s_and_b32 vcc_lo, vcc_lo, 8224
    s_cbranch_scc1 L_rty_48
L_ok_49:
    s_xor_b32 s48, s3, 5
    s_lshl_b32 s48, s48, 14
    s_add_u32 s48, s48, s65
    s_add_u32 m0, s68, 40960
    s_nop 0
    buffer_load_dwordx4 v1, s[36:39], s48 offen sc1 lds
    s_add_u32 m0, s68, 113664
    s_nop 0
    buffer_load_dwordx4 v1, s[36:39], s48 offen offset:1024 sc1 lds
    s_add_u32 s48, s48, 8192
    s_add_u32 m0, s68, 45056
    s_nop 0
    buffer_load_dwordx4 v1, s[36:39], s48 offen sc1 lds
    s_add_u32 m0, s68, 117760
    s_nop 0
    buffer_load_dwordx4 v1, s[36:39], s48 offen offset:1024 sc1 lds
L_ld_46:
    buffer_store_dwordx4 v[128:131], v1, s[36:39], s69 offen offset:0 sc1
    v_cvt_pk_bf16_f32 v48, v48, v49
    v_exp_f32 v51, v51
    v_exp_f32 v52, v52
    v_cvt_pk_bf16_f32 v49, v50, v51
    v_exp_f32 v53, v53
    v_exp_f32 v54, v54
    v_exp_f32 v55, v55
    v_cvt_pk_bf16_f32 v50, v52, v53
    v_cvt_pk_bf16_f32 v51, v54, v55
    v_exp_f32 v56, v56
    v_exp_f32 v57, v57
    v_mfma_f32_32x32x16_bf16 v[24:39], v[20:23], v[48:51], v[24:39]
    s_mov_b64 exec, s[10:11]
    ds_read_b128 v[16:19], v3 offset:15360
    ds_read_b128 v[20:23], v3 offset:15872
    s_mov_b64 exec, -1
    v_exp_f32 v58, v58
    v_cvt_pk_bf16_f32 v56, v56, v57
    v_exp_f32 v59, v59
    v_exp_f32 v60, v60
    v_cvt_pk_bf16_f32 v57, v58, v59
    v_exp_f32 v61, v61
    s_waitcnt lgkmcnt(2)
    v_mfma_f32_32x32x16_bf16 v[40:55], v[12:15], v[8:11], 0
    ds_read_b128 v[12:15], v1 offset:17408
    v_exp_f32 v62, v62
    v_cvt_pk_bf16_f32 v58, v60, v61
    v_exp_f32 v63, v63
    v_exp_f32 v64, v64
    v_cvt_pk_bf16_f32 v59, v62, v63
    v_exp_f32 v65, v65
    v_exp_f32 v66, v66
    s_waitcnt lgkmcnt(1)
    v_mfma_f32_32x32x16_bf16 v[24:39], v[16:19], v[56:59], v[24:39]
    v_cvt_pk_bf16_f32 v64, v64, v65
    v_exp_f32 v67, v67
    v_exp_f32 v68, v68
    v_cvt_pk_bf16_f32 v65, v66, v67
    v_exp_f32 v69, v69
    v_exp_f32 v70, v70
    v_exp_f32 v71, v71
    v_cvt_pk_bf16_f32 v66, v68, v69
    v_cvt_pk_bf16_f32 v67, v70, v71
    v_exp_f32 v40, v40
    v_exp_f32 v41, v41
    v_mfma_f32_32x32x16_bf16 v[24:39], v[20:23], v[64:67], v[24:39]
    s_mov_b64 exec, s[10:11]
    ds_read_b128 v[16:19], v3 offset:16384
    ds_read_b128 v[20:23], v3 offset:16896
    s_mov_b64 exec, -1
    v_exp_f32 v42, v42
    v_cvt_pk_bf16_f32 v40, v40, v41
    v_exp_f32 v43, v43
    v_exp_f32 v44, v44
    v_cvt_pk_bf16_f32 v41, v42, v43
    v_exp_f32 v45, v45
    s_waitcnt lgkmcnt(2)
    v_mfma_f32_32x32x16_bf16 v[56:71], v[12:15], v[8:11], 0
    ds_read_b128 v[12:15], v1 offset:18432
    v_exp_f32 v46, v46
    v_cvt_pk_bf16_f32 v42, v44, v45
    v_exp_f32 v47, v47
    v_exp_f32 v48, v48
    v_cvt_pk_bf16_f32 v43, v46, v47
    v_exp_f32 v49, v49
    v_exp_f32 v50, v50
    s_waitcnt lgkmcnt(1)
    v_mfma_f32_32x32x16_bf16 v[24:39], v[16:19], v[40:43], v[24:39]
    s_cmp_ge_u32 s5, 4
    s_cbranch_scc1 L_ld_50
L_chk_51:
    v_cmp_ne_u64 vcc, s[6:7], v[124:125]
    s_nop 0
    s_and_b32 vcc_lo, vcc_lo, 16448
    s_cbranch_scc1 L_rty_52
L_ok_53:
    s_xor_b32 s48, s3, 6
    s_lshl_b32 s48, s48, 14
    s_add_u32 s48, s48, s65
    s_add_u32 m0, s68, 49152
    s_nop 0
    buffer_load_dwordx4 v1, s[36:39], s48 offen sc1 lds
    s_add_u32 m0, s68, 121856
    s_nop 0
    buffer_load_dwordx4 v1, s[36:39], s48 offen offset:1024 sc1 lds
    s_add_u32 s48, s48, 8192
    s_add_u32 m0, s68, 53248
    s_nop 0
    buffer_load_dwordx4 v1, s[36:39], s48 offen sc1 lds
    s_add_u32 m0, s68, 125952
    s_nop 0
    buffer_load_dwordx4 v1, s[36:39], s48 offen offset:1024 sc1 lds
L_ld_50:
    s_sub_u32 s48, s5, 1
    s_cmp_lt_u32 s48, 2
    s_cbranch_scc1 L_w12_54
L_w12d_55:
    v_cvt_pk_bf16_f32 v48, v48, v49
    v_exp_f32 v51, v51
    v_exp_f32 v52, v52
    v_cvt_pk_bf16_f32 v49, v50, v51
    v_exp_f32 v53, v53
    v_exp_f32 v54, v54
    v_exp_f32 v55, v55
    v_cvt_pk_bf16_f32 v50, v52, v53
    v_cvt_pk_bf16_f32 v51, v54, v55
    v_exp_f32 v56, v56
    v_exp_f32 v57, v57
    v_mfma_f32_32x32x16_bf16 v[24:39], v[20:23], v[48:51], v[24:39]
    s_mov_b64 exec, s[10:11]
    ds_read_b128 v[16:19], v3 offset:17408
    ds_read_b128 v[20:23], v3 offset:17920
    s_mov_b64 exec, -1
    v_exp_f32 v58, v58
    v_cvt_pk_bf16_f32 v56, v56, v57
    v_exp_f32 v59, v59
    v_exp_f32 v60, v60
    v_cvt_pk_bf16_f32 v57, v58, v59
    v_exp_f32 v61, v61
    s_waitcnt lgkmcnt(2)
    v_mfma_f32_32x32x16_bf16 v[40:55], v[12:15], v[8:11], 0
    ds_read_b128 v[12:15], v1 offset:19456
    v_exp_f32 v62, v62
    v_cvt_pk_bf16_f32 v58, v60, v61
    v_exp_f32 v63, v63
    v_exp_f32 v64, v64
    v_cvt_pk_bf16_f32 v59, v62, v63
    v_exp_f32 v65, v65
    v_exp_f32 v66, v66
    s_waitcnt lgkmcnt(1)
    v_mfma_f32_32x32x16_bf16 v[24:39], v[16:19], v[56:59], v[24:39]
    buffer_load_dwordx4 v[112:115], v1, s[36:39], s78 offen offset:0 sc1
    buffer_load_dwordx4 v[116:119], v1, s[36:39], s78 offen offset:1024 sc1
    s_cmp_eq_u32 s5, 7
    s_cbranch_scc1 L_nt_59
    buffer_store_dwordx4 v[128:131], v1, s[36:39], s72 offen offset:0 sc1
L_nt_59:
    v_cvt_pk_bf16_f32 v64, v64, v65
    v_exp_f32 v67, v67
    v_exp_f32 v68, v68
    v_cvt_pk_bf16_f32 v65, v66, v67
    v_exp_f32 v69, v69
    v_exp_f32 v70, v70
    v_exp_f32 v71, v71
    v_cvt_pk_bf16_f32 v66, v68, v69
    v_cvt_pk_bf16_f32 v67, v70, v71
    v_exp_f32 v40, v40
    v_exp_f32 v41, v41
    v_mfma_f32_32x32x16_bf16 v[24:39], v[20:23], v[64:67], v[24:39]
    s_mov_b64 exec, s[10:11]
    ds_read_b128 v[16:19], v3 offset:18432
    ds_read_b128 v[20:23], v3 offset:18944
    s_mov_b64 exec, -1
    v_exp_f32 v42, v42
    v_cvt_pk_bf16_f32 v40, v40, v41
    v_exp_f32 v43, v43
    v_exp_f32 v44, v44
    v_cvt_pk_bf16_f32 v41, v42, v43
    v_exp_f32 v45, v45
    s_waitcnt lgkmcnt(2)
    v_mfma_f32_32x32x16_bf16 v[56:71], v[12:15], v[8:11], 0
    ds_read_b128 v[12:15], v1 offset:20480
    v_exp_f32 v46, v46
    v_cvt_pk_bf16_f32 v42, v44, v45
    v_exp_f32 v47, v47
    v_exp_f32 v48, v48
    v_cvt_pk_bf16_f32 v43, v46, v47
    v_exp_f32 v49, v49
    v_exp_f32 v50, v50
    s_waitcnt lgkmcnt(1)
    v_mfma_f32_32x32x16_bf16 v[24:39], v[16:19], v[40:43], v[24:39]
    v_cvt_pk_bf16_f32 v48, v48, v49
    v_exp_f32 v51, v51
    v_exp_f32 v52, v52
    v_cvt_pk_bf16_f32 v49, v50, v51
    v_exp_f32 v53, v53
    v_exp_f32 v54, v54
    v_exp_f32 v55, v55
    v_cvt_pk_bf16_f32 v50, v52, v53
    v_cvt_pk_bf16_f32 v51, v54, v55
    v_exp_f32 v56, v56
    v_exp_f32 v57, v57
    v_mfma_f32_32x32x16_bf16 v[24:39], v[20:23], v[48:51], v[24:39]
    s_mov_b64 exec, s[10:11]
    ds_read_b128 v[16:19], v3 offset:19456
    ds_read_b128 v[20:23], v3 offset:19968
    s_mov_b64 exec, -1
    v_exp_f32 v58, v58
    v_cvt_pk_bf16_f32 v56, v56, v57
    v_exp_f32 v59, v59
    v_exp_f32 v60, v60
    v_cvt_pk_bf16_f32 v57, v58, v59
    v_exp_f32 v61, v61
    s_waitcnt lgkmcnt(2)
    v_mfma_f32_32x32x16_bf16 v[40:55], v[12:15], v[8:11], 0
    ds_read_b128 v[12:15], v1 offset:21504
    v_exp_f32 v62, v62
    v_cvt_pk_bf16_f32 v58, v60, v61
    v_exp_f32 v63, v63
    v_exp_f32 v64, v64
    v_cvt_pk_bf16_f32 v59, v62, v63
    v_exp_f32 v65, v65
    v_exp_f32 v66, v66
    s_waitcnt lgkmcnt(1)
    v_mfma_f32_32x32x16_bf16 v[24:39], v[16:19], v[56:59], v[24:39]
    v_cvt_pk_bf16_f32 v64, v64, v65
    v_exp_f32 v67, v67
    v_exp_f32 v68, v68
    v_cvt_pk_bf16_f32 v65, v66, v67
    v_exp_f32 v69, v69
    v_exp_f32 v70, v70
    v_exp_f32 v71, v71
    v_cvt_pk_bf16_f32 v66, v68, v69
    v_cvt_pk_bf16_f32 v67, v70, v71
    v_exp_f32 v40, v40
    v_exp_f32 v41, v41
    v_mfma_f32_32x32x16_bf16 v[24:39], v[20:23], v[64:67], v[24:39]
    s_mov_b64 exec, s[10:11]
    ds_read_b128 v[16:19], v3 offset:20480
    ds_read_b128 v[20:23], v3 offset:20992
    s_mov_b64 exec, -1
    v_exp_f32 v42, v42
    v_cvt_pk_bf16_f32 v40, v40, v41
    v_exp_f32 v43, v43
    v_exp_f32 v44, v44
    v_cvt_pk_bf16_f32 v41, v42, v43
    v_exp_f32 v45, v45
    s_waitcnt lgkmcnt(2)
    v_mfma_f32_32x32x16_bf16 v[56:71], v[12:15], v[8:11], 0
    ds_read_b128 v[12:15], v1 offset:22528
    v_exp_f32 v46, v46
    v_cvt_pk_bf16_f32 v42, v44, v45
    v_exp_f32 v47, v47
    v_exp_f32 v48, v48
    v_cvt_pk_bf16_f32 v43, v46, v47
    v_exp_f32 v49, v49
    v_exp_f32 v50, v50
    s_waitcnt lgkmcnt(1)
    v_mfma_f32_32x32x16_bf16 v[24:39], v[16:19], v[40:43], v[24:39]
    s_waitcnt vmcnt(0)
L_chk_60:
    v_cmp_ne_u64 vcc, s[6:7], v[112:113]
    v_cmp_ne_u64 s[50:51], s[6:7], v[114:115]
    v_cmp_ne_u64 s[52:53], s[6:7], v[116:117]
    v_cmp_ne_u64 s[54:55], s[6:7], v[118:119]
    s_or_b64 vcc, vcc, s[50:51]
    s_or_b64 s[52:53], s[52:53], s[54:55]
    s_or_b64 vcc, vcc, s[52:53]
    s_cbranch_scc1 L_rty_61
L_ok_62:
    s_cmp_ge_u32 s5, 4
    s_cbranch_scc1 L_ld_63
L_chk_64:
    v_cmp_ne_u64 vcc, s[6:7], v[124:125]
    s_nop 0
    s_and_b32 vcc_lo, vcc_lo, 32896
    s_cbranch_scc1 L_rty_65
L_ok_66:
    s_xor_b32 s48, s3, 7
    s_lshl_b32 s48, s48, 14
    s_add_u32 s48, s48, s65
    s_add_u32 m0, s68, 57344
    s_nop 0
    buffer_load_dwordx4 v1, s[36:39], s48 offen sc1 lds
    s_add_u32 m0, s68, 130048
    s_nop 0
    buffer_load_dwordx4 v1, s[36:39], s48 offen offset:1024 sc1 lds
    s_add_u32 s48, s48, 8192
    s_add_u32 m0, s68, 61440
    s_nop 0
    buffer_load_dwordx4 v1, s[36:39], s48 offen sc1 lds
    s_add_u32 m0, s68, 134144
    s_nop 0
    buffer_load_dwordx4 v1, s[36:39], s48 offen offset:1024 sc1 lds
L_ld_63:
    buffer_load_dwordx4 v[136:139], v1, s[36:39], s76 offen offset:0 sc1
    buffer_load_dwordx4 v[140:143], v1, s[36:39], s76 offen offset:1024 sc1
    s_cmp_eq_u32 s5, 7
    s_cbranch_scc1 L_nt_67
    buffer_store_dwordx4 v[128:131], v1, s[36:39], s72 offen offset:1024 sc1
L_nt_67:
    v_cvt_pk_bf16_f32 v48, v48, v49
    v_exp_f32 v51, v51
    v_exp_f32 v52, v52
    v_cvt_pk_bf16_f32 v49, v50, v51
    v_exp_f32 v53, v53
    v_exp_f32 v54, v54
    v_exp_f32 v55, v55
    v_cvt_pk_bf16_f32 v50, v52, v53
    v_cvt_pk_bf16_f32 v51, v54, v55
    v_exp_f32 v56, v56
    v_exp_f32 v57, v57
    v_mfma_f32_32x32x16_bf16 v[24:39], v[20:23], v[48:51], v[24:39]
    s_mov_b64 exec, s[10:11]
    ds_read_b128 v[16:19], v3 offset:21504
    ds_read_b128 v[20:23], v3 offset:22016
    s_mov_b64 exec, -1
    v_exp_f32 v58, v58
    v_cvt_pk_bf16_f32 v56, v56, v57
    v_exp_f32 v59, v59
    v_exp_f32 v60, v60
    v_cvt_pk_bf16_f32 v57, v58, v59
    v_exp_f32 v61, v61
    s_waitcnt lgkmcnt(2)
    v_mfma_f32_32x32x16_bf16 v[40:55], v[12:15], v[8:11], 0
    ds_read_b128 v[12:15], v1 offset:23552
    v_exp_f32 v62, v62
    v_cvt_pk_bf16_f32 v58, v60, v61
    v_exp_f32 v63, v63
    v_exp_f32 v64, v64
    v_cvt_pk_bf16_f32 v59, v62, v63
    v_exp_f32 v65, v65
    v_exp_f32 v66, v66
    s_waitcnt lgkmcnt(1)
    v_mfma_f32_32x32x16_bf16 v[24:39], v[16:19], v[56:59], v[24:39]
    buffer_load_dwordx4 v[144:147], v1, s[36:39], s76 offen offset:2048 sc1
    v_cvt_pk_bf16_f32 v64, v64, v65
    v_exp_f32 v67, v67
    v_exp_f32 v68, v68
    v_cvt_pk_bf16_f32 v65, v66, v67
    v_exp_f32 v69, v69
    v_exp_f32 v70, v70
    v_exp_f32 v71, v71
    v_cvt_pk_bf16_f32 v66, v68, v69
    v_cvt_pk_bf16_f32 v67, v70, v71
    s_setprio 2
    v_exp_f32 v40, v40
    v_exp_f32 v41, v41
    v_mfma_f32_32x32x16_bf16 v[24:39], v[20:23], v[64:67], v[24:39]
    s_mov_b64 exec, s[10:11]
    ds_read_b128 v[16:19], v3 offset:22528
    ds_read_b128 v[20:23], v3 offset:23040
    s_mov_b64 exec, -1
    v_exp_f32 v42, v42
    v_cvt_pk_bf16_f32 v40, v40, v41
    v_exp_f32 v43, v43
    v_exp_f32 v44, v44
    v_cvt_pk_bf16_f32 v41, v42, v43
    v_exp_f32 v45, v45
    s_waitcnt lgkmcnt(2)
    v_mfma_f32_32x32x16_bf16 v[56:71], v[12:15], v[8:11], 0
    ds_read_b128 v[12:15], v1 offset:24576
    v_exp_f32 v46, v46
    v_cvt_pk_bf16_f32 v42, v44, v45
    v_exp_f32 v47, v47
    v_exp_f32 v48, v48
    v_cvt_pk_bf16_f32 v43, v46, v47
    v_exp_f32 v49, v49
    v_exp_f32 v50, v50
    s_waitcnt lgkmcnt(1)
    v_mfma_f32_32x32x16_bf16 v[24:39], v[16:19], v[40:43], v[24:39]
    buffer_load_dwordx4 v[148:151], v1, s[36:39], s76 offen offset:3072 sc1
    v_cvt_pk_bf16_f32 v48, v48, v49
    v_exp_f32 v51, v51
    v_exp_f32 v52, v52
    v_cvt_pk_bf16_f32 v49, v50, v51
    v_exp_f32 v53, v53
    v_exp_f32 v54, v54
    v_exp_f32 v55, v55
    v_cvt_pk_bf16_f32 v50, v52, v53
    v_cvt_pk_bf16_f32 v51, v54, v55
    v_exp_f32 v56, v56
    v_exp_f32 v57, v57
    v_mfma_f32_32x32x16_bf16 v[24:39], v[20:23], v[48:51], v[24:39]
    s_mov_b64 exec, s[10:11]
    ds_read_b128 v[16:19], v3 offset:23552
    ds_read_b128 v[20:23], v3 offset:24064
    s_mov_b64 exec, -1
    v_exp_f32 v58, v58
    v_cvt_pk_bf16_f32 v56, v56, v57
    v_exp_f32 v59, v59
    v_exp_f32 v60, v60
    v_cvt_pk_bf16_f32 v57, v58, v59
    v_exp_f32 v61, v61
    s_waitcnt lgkmcnt(2)
    v_mfma_f32_32x32x16_bf16 v[40:55], v[12:15], v[8:11], 0
    ds_read_b128 v[12:15], v1 offset:25600
    v_exp_f32 v62, v62
    v_cvt_pk_bf16_f32 v58, v60, v61
    v_exp_f32 v63, v63
    v_exp_f32 v64, v64
    v_cvt_pk_bf16_f32 v59, v62, v63
    v_exp_f32 v65, v65
    v_exp_f32 v66, v66
    s_waitcnt lgkmcnt(1)
    v_mfma_f32_32x32x16_bf16 v[24:39], v[16:19], v[56:59], v[24:39]
    s_xor_b32 s76, s76, 4096
    buffer_load_dwordx4 v[152:155], v1, s[36:39], s76 offen offset:0 sc1
    s_cmp_eq_u32 s5, 7
    s_cbranch_scc1 L_nt_68
    buffer_store_dwordx4 v[128:131], v1, s[36:39], s73 offen offset:0 sc1
L_nt_68:
    v_cvt_pk_bf16_f32 v64, v64, v65
    v_exp_f32 v67, v67
    v_exp_f32 v68, v68
    v_cvt_pk_bf16_f32 v65, v66, v67
    v_exp_f32 v69, v69
    v_exp_f32 v70, v70
    v_exp_f32 v71, v71
    v_cvt_pk_bf16_f32 v66, v68, v69
    v_cvt_pk_bf16_f32 v67, v70, v71
    v_exp_f32 v40, v40
    v_exp_f32 v41, v41
    v_mfma_f32_32x32x16_bf16 v[24:39], v[20:23], v[64:67], v[24:39]
    s_mov_b64 exec, s[10:11]
    ds_read_b128 v[16:19], v3 offset:24576
    ds_read_b128 v[20:23], v3 offset:25088
    s_mov_b64 exec, -1
    v_exp_f32 v42, v42
    v_cvt_pk_bf16_f32 v40, v40, v41
    v_exp_f32 v43, v43
    v_exp_f32 v44, v44
    v_cvt_pk_bf16_f32 v41, v42, v43
    v_exp_f32 v45, v45
    s_waitcnt lgkmcnt(2)
    v_mfma_f32_32x32x16_bf16 v[56:71], v[12:15], v[8:11], 0
    ds_read_b128 v[12:15], v1 offset:26624
    v_exp_f32 v46, v46
    v_cvt_pk_bf16_f32 v42, v44, v45
    v_exp_f32 v47, v47
    v_exp_f32 v48, v48
    v_cvt_pk_bf16_f32 v43, v46, v47
    v_exp_f32 v49, v49
    v_exp_f32 v50, v50
    s_waitcnt lgkmcnt(1)
    v_mfma_f32_32x32x16_bf16 v[24:39], v[16:19], v[40:43], v[24:39]
    v_lshrrev_b32 v121, 5, v0
    v_lshlrev_b32 v121, 12, v121
    v_add_u32 v121, v121, v122
    s_lshl_b32 s94, s5, 9
    s_add_u32 s94, s94, 1441792
    buffer_load_dwordx4 v[112:115], v121, s[36:39], s94 offen sc1
    buffer_load_dwordx4 v[156:159], v1, s[36:39], s76 offen offset:1024 sc1
    v_cvt_pk_bf16_f32 v48, v48, v49
    v_exp_f32 v51, v51
    v_exp_f32 v52, v52
    v_cvt_pk_bf16_f32 v49, v50, v51
    v_exp_f32 v53, v53
    v_exp_f32 v54, v54
    v_exp_f32 v55, v55
    v_cvt_pk_bf16_f32 v50, v52, v53
    v_cvt_pk_bf16_f32 v51, v54, v55
    v_exp_f32 v56, v56
    v_exp_f32 v57, v57
    v_mfma_f32_32x32x16_bf16 v[24:39], v[20:23], v[48:51], v[24:39]
    s_mov_b64 exec, s[10:11]
    ds_read_b128 v[16:19], v3 offset:25600
    ds_read_b128 v[20:23], v3 offset:26112
    s_mov_b64 exec, -1
    v_exp_f32 v58, v58
    v_cvt_pk_bf16_f32 v56, v56, v57
    v_exp_f32 v59, v59
    v_exp_f32 v60, v60
    v_cvt_pk_bf16_f32 v57, v58, v59
    v_exp_f32 v61, v61
    s_waitcnt lgkmcnt(2)
    v_mfma_f32_32x32x16_bf16 v[40:55], v[12:15], v[8:11], 0
    ds_read_b128 v[12:15], v1 offset:27648
    v_exp_f32 v62, v62
    v_cvt_pk_bf16_f32 v58, v60, v61
    v_exp_f32 v63, v63
    v_exp_f32 v64, v64
    v_cvt_pk_bf16_f32 v59, v62, v63
    v_exp_f32 v65, v65
    v_exp_f32 v66, v66
    s_waitcnt lgkmcnt(1)
    v_mfma_f32_32x32x16_bf16 v[24:39], v[16:19], v[56:59], v[24:39]
    buffer_load_dwordx4 v[160:163], v1, s[36:39], s76 offen offset:2048 sc1
    v_cvt_pk_bf16_f32 v64, v64, v65
    v_exp_f32 v67, v67
    v_exp_f32 v68, v68
    v_cvt_pk_bf16_f32 v65, v66, v67
    v_exp_f32 v69, v69
    v_exp_f32 v70, v70
    v_exp_f32 v71, v71
    v_cvt_pk_bf16_f32 v66, v68, v69
    v_cvt_pk_bf16_f32 v67, v70, v71
    s_setprio 1
    v_exp_f32 v40, v40
    v_exp_f32 v41, v41
    v_mfma_f32_32x32x16_bf16 v[24:39], v[20:23], v[64:67], v[24:39]
    s_mov_b64 exec, s[10:11]
    ds_read_b128 v[16:19], v3 offset:26624
    ds_read_b128 v[20:23], v3 offset:27136
    s_mov_b64 exec, -1
    v_exp_f32 v42, v42
    v_cvt_pk_bf16_f32 v40, v40, v41
    v_exp_f32 v43, v43
    v_exp_f32 v44, v44
    v_cvt_pk_bf16_f32 v41, v42, v43
    v_exp_f32 v45, v45
    s_waitcnt lgkmcnt(2)
    v_mfma_f32_32x32x16_bf16 v[56:71], v[12:15], v[8:11], 0
    ds_read_b128 v[12:15], v1 offset:28672
    v_exp_f32 v46, v46
    v_cvt_pk_bf16_f32 v42, v44, v45
    v_exp_f32 v47, v47
    v_exp_f32 v48, v48
    v_cvt_pk_bf16_f32 v43, v46, v47
    v_exp_f32 v49, v49
    v_exp_f32 v50, v50
    s_waitcnt lgkmcnt(1)
    v_mfma_f32_32x32x16_bf16 v[24:39], v[16:19], v[40:43], v[24:39]
    buffer_load_dwordx4 v[164:167], v1, s[36:39], s76 offen offset:3072 sc1
    s_xor_b32 s76, s76, 12288
    buffer_load_dwordx4 v[168:171], v1, s[36:39], s76 offen offset:0 sc1
    s_cmp_eq_u32 s5, 7
    s_cbranch_scc1 L_nt_69
    buffer_store_dwordx4 v[128:131], v1, s[36:39], s73 offen offset:1024 sc1
L_nt_69:
    v_cvt_pk_bf16_f32 v48, v48, v49
    v_exp_f32 v51, v51
    v_exp_f32 v52, v52
    v_cvt_pk_bf16_f32 v49, v50, v51
    v_exp_f32 v53, v53
    v_exp_f32 v54, v54
    v_exp_f32 v55, v55
    v_cvt_pk_bf16_f32 v50, v52, v53
    v_cvt_pk_bf16_f32 v51, v54, v55
    v_exp_f32 v56, v56
    v_exp_f32 v57, v57
    v_mfma_f32_32x32x16_bf16 v[24:39], v[20:23], v[48:51], v[24:39]
    s_mov_b64 exec, s[10:11]
    ds_read_b128 v[16:19], v3 offset:27648
    ds_read_b128 v[20:23], v3 offset:28160
    s_mov_b64 exec, -1
    v_exp_f32 v58, v58
    v_cvt_pk_bf16_f32 v56, v56, v57
    v_exp_f32 v59, v59
    v_exp_f32 v60, v60
    v_cvt_pk_bf16_f32 v57, v58, v59
    v_exp_f32 v61, v61
    s_waitcnt lgkmcnt(2)
    v_mfma_f32_32x32x16_bf16 v[40:55], v[12:15], v[8:11], 0
    ds_read_b128 v[12:15], v1 offset:29696
    v_exp_f32 v62, v62
    v_cvt_pk_bf16_f32 v58, v60, v61
    v_exp_f32 v63, v63
    v_exp_f32 v64, v64
    v_cvt_pk_bf16_f32 v59, v62, v63
    v_exp_f32 v65, v65
    v_exp_f32 v66, v66
    s_waitcnt lgkmcnt(1)
    v_mfma_f32_32x32x16_bf16 v[24:39], v[16:19], v[56:59], v[24:39]
    s_waitcnt vmcnt(4)
L_chk_70:
    v_cmp_ne_u32 vcc, s6, v113
    v_cmp_ne_u32 s[56:57], s7, v115
    s_nop 0
    s_or_b64 vcc, vcc, s[56:57]
    s_cbranch_scc1 L_rty_71
L_ok_72:
    v_and_b32 v117, 4294901760, v112
    v_lshlrev_b32 v116, 16, v112
    v_lshrrev_b32 v6, 5, v0
    v_cvt_f32_u32 v118, v6
    v_lshlrev_b32 v6, 11, v6
    v_add_f32 v116, v116, v118
    v_add_f32 v117, v117, v118
    v_lshrrev_b32 v118, 2, v122
    v_cvt_pk_bf16_f32 v116, v116, v117
    v_add_u32 v6, v118, v6
    s_lshl_b32 s48, s5, 7
    s_add_u32 s48, s48, 65536
    v_add_u32 v6, s48, v6
    ds_write_b32 v6, v116
    ds_write_b32 v6, v114 offset:1024
    buffer_load_dwordx4 v[172:175], v1, s[36:39], s76 offen offset:1024 sc1
    v_cvt_pk_bf16_f32 v64, v64, v65
    v_exp_f32 v67, v67
    v_exp_f32 v68, v68
    v_cvt_pk_bf16_f32 v65, v66, v67
    v_exp_f32 v69, v69
    v_exp_f32 v70, v70
    v_exp_f32 v71, v71
    v_cvt_pk_bf16_f32 v66, v68, v69
    v_cvt_pk_bf16_f32 v67, v70, v71
    v_exp_f32 v40, v40
    v_exp_f32 v41, v41
    v_mfma_f32_32x32x16_bf16 v[24:39], v[20:23], v[64:67], v[24:39]
    s_mov_b64 exec, s[10:11]
    ds_read_b128 v[16:19], v3 offset:28672
    ds_read_b128 v[20:23], v3 offset:29184
    s_mov_b64 exec, -1
    v_exp_f32 v42, v42
    v_cvt_pk_bf16_f32 v40, v40, v41
    v_exp_f32 v43, v43
    v_exp_f32 v44, v44
    v_cvt_pk_bf16_f32 v41, v42, v43
    v_exp_f32 v45, v45
    s_waitcnt lgkmcnt(4)
    v_mfma_f32_32x32x16_bf16 v[56:71], v[12:15], v[8:11], 0
    ds_read_b128 v[12:15], v1 offset:30720
    v_exp_f32 v46, v46
    v_cvt_pk_bf16_f32 v42, v44, v45
    v_exp_f32 v47, v47
    v_exp_f32 v48, v48
    v_cvt_pk_bf16_f32 v43, v46, v47
    v_exp_f32 v49, v49
    v_exp_f32 v50, v50
    s_waitcnt lgkmcnt(1)
    v_mfma_f32_32x32x16_bf16 v[24:39], v[16:19], v[40:43], v[24:39]
    buffer_load_dwordx4 v[176:179], v1, s[36:39], s76 offen offset:2048 sc1
    s_lshl_b32 s48, s86, 15
    s_add_u32 s48, s48, s89
    s_lshl_b32 s49, s84, 8
    s_add_u32 s48, s48, s49
    v_lshrrev_b32 v6, 4, v0
    v_lshlrev_b32 v6, 10, v6
    v_and_b32 v5, 240, v1
    v_add_u32 v6, v6, v5
    s_add_u32 m0, s68, 155648
    s_nop 0
    buffer_load_dwordx4 v6, s[12:15], s48 offen lds
    v_cvt_pk_bf16_f32 v48, v48, v49
    v_exp_f32 v51, v51
    v_exp_f32 v52, v52
    v_cvt_pk_bf16_f32 v49, v50, v51
    v_exp_f32 v53, v53
    v_exp_f32 v54, v54
    v_exp_f32 v55, v55
    v_cvt_pk_bf16_f32 v50, v52, v53
    v_cvt_pk_bf16_f32 v51, v54, v55
    s_setprio 0
    v_exp_f32 v56, v56
    v_exp_f32 v57, v57
    v_mfma_f32_32x32x16_bf16 v[24:39], v[20:23], v[48:51], v[24:39]
    s_mov_b64 exec, s[10:11]
    ds_read_b128 v[16:19], v3 offset:29696
    ds_read_b128 v[20:23], v3 offset:30208
    s_mov_b64 exec, -1
    v_exp_f32 v58, v58
    v_cvt_pk_bf16_f32 v56, v56, v57
    v_exp_f32 v59, v59
    v_exp_f32 v60, v60
    v_cvt_pk_bf16_f32 v57, v58, v59
    v_exp_f32 v61, v61
    s_waitcnt lgkmcnt(2)
    v_mfma_f32_32x32x16_bf16 v[40:55], v[12:15], v[8:11], 0
    ds_read_b128 v[12:15], v1 offset:31744
    v_exp_f32 v62, v62
    v_cvt_pk_bf16_f32 v58, v60, v61
    v_exp_f32 v63, v63
    v_exp_f32 v64, v64
    v_cvt_pk_bf16_f32 v59, v62, v63
    v_exp_f32 v65, v65
    v_exp_f32 v66, v66
    s_waitcnt lgkmcnt(1)
    v_mfma_f32_32x32x16_bf16 v[24:39], v[16:19], v[56:59], v[24:39]
    buffer_load_dwordx4 v[180:183], v1, s[36:39], s76 offen offset:3072 sc1
    v_cvt_pk_bf16_f32 v64, v64, v65
    v_exp_f32 v67, v67
    v_exp_f32 v68, v68
    v_cvt_pk_bf16_f32 v65, v66, v67
    v_exp_f32 v69, v69
    v_exp_f32 v70, v70
    v_exp_f32 v71, v71
    v_cvt_pk_bf16_f32 v66, v68, v69
    v_cvt_pk_bf16_f32 v67, v70, v71
    s_waitcnt vmcnt(3)
    s_waitcnt lgkmcnt(0)
    s_barrier
    s_cmp_eq_u32 s5, 3
    s_cbranch_scc1 L_pf_73
L_pfd_74:
    s_setprio 3
    v_exp_f32 v40, v40
    v_exp_f32 v41, v41
    v_mfma_f32_32x32x16_bf16 v[24:39], v[20:23], v[64:67], v[24:39]
    s_mov_b64 exec, s[10:11]
    ds_read_b128 v[16:19], v3 offset:30720
    ds_read_b128 v[20:23], v3 offset:31232
    s_mov_b64 exec, -1
    v_exp_f32 v42, v42
    v_cvt_pk_bf16_f32 v40, v40, v41
    v_exp_f32 v43, v43
    v_exp_f32 v44, v44
    v_cvt_pk_bf16_f32 v41, v42, v43
    v_exp_f32 v45, v45
    v_mfma_f32_32x32x16_bf16 v[56:71], v[12:15], v[8:11], 0
    ds_read_b128 v[12:15], v1 offset:32768
    v_exp_f32 v46, v46
    v_cvt_pk_bf16_f32 v42, v44, v45
    v_exp_f32 v47, v47
    v_exp_f32 v48, v48
    v_cvt_pk_bf16_f32 v43, v46, v47
    v_exp_f32 v49, v49
    v_exp_f32 v50, v50
    s_waitcnt lgkmcnt(1)
    v_mfma_f32_32x32x16_bf16 v[24:39], v[16:19], v[40:43], v[24:39]
    s_xor_b32 s76, s76, 4096
    buffer_load_dwordx4 v[184:187], v1, s[36:39], s76 offen offset:0 sc1
    v_cvt_pk_bf16_f32 v48, v48, v49
    v_exp_f32 v51, v51
    v_exp_f32 v52, v52
    v_cvt_pk_bf16_f32 v49, v50, v51
    v_exp_f32 v53, v53
    v_exp_f32 v54, v54
    v_exp_f32 v55, v55
    v_cvt_pk_bf16_f32 v50, v52, v53
    v_cvt_pk_bf16_f32 v51, v54, v55
    v_exp_f32 v56, v56
    v_exp_f32 v57, v57
    v_mfma_f32_32x32x16_bf16 v[24:39], v[20:23], v[48:51], v[24:39]
    s_mov_b64 exec, s[10:11]
    ds_read_b128 v[16:19], v3 offset:31744
    ds_read_b128 v[20:23], v3 offset:32256
    s_mov_b64 exec, -1
    v_exp_f32 v58, v58
    v_cvt_pk_bf16_f32 v56, v56, v57
    v_exp_f32 v59, v59
    v_exp_f32 v60, v60
    v_cvt_pk_bf16_f32 v57, v58, v59
    v_exp_f32 v61, v61
    s_waitcnt lgkmcnt(2)
    v_mfma_f32_32x32x16_bf16 v[40:55], v[12:15], v[8:11], 0
    ds_read_b128 v[12:15], v1 offset:33792
    v_exp_f32 v62, v62
    v_cvt_pk_bf16_f32 v58, v60, v61
    v_exp_f32 v63, v63
    v_exp_f32 v64, v64
    v_cvt_pk_bf16_f32 v59, v62, v63
    v_exp_f32 v65, v65
    v_exp_f32 v66, v66
    s_waitcnt lgkmcnt(1)
    v_mfma_f32_32x32x16_bf16 v[24:39], v[16:19], v[56:59], v[24:39]
    buffer_load_dwordx4 v[188:191], v1, s[36:39], s76 offen offset:1024 sc1
    v_cvt_pk_bf16_f32 v64, v64, v65
    v_exp_f32 v67, v67
    v_exp_f32 v68, v68
    v_cvt_pk_bf16_f32 v65, v66, v67
    v_exp_f32 v69, v69
    v_exp_f32 v70, v70
    v_exp_f32 v71, v71
    v_cvt_pk_bf16_f32 v66, v68, v69
    v_cvt_pk_bf16_f32 v67, v70, v71
    v_exp_f32 v40, v40
    v_exp_f32 v41, v41
    v_mfma_f32_32x32x16_bf16 v[24:39], v[20:23], v[64:67], v[24:39]
    s_mov_b64 exec, s[10:11]
    ds_read_b128 v[16:19], v3 offset:32768
    ds_read_b128 v[20:23], v3 offset:33280
    s_mov_b64 exec, -1
    v_exp_f32 v42, v42
    v_cvt_pk_bf16_f32 v40, v40, v41
    v_exp_f32 v43, v43
    v_exp_f32 v44, v44
    v_cvt_pk_bf16_f32 v41, v42, v43
    v_exp_f32 v45, v45
    s_waitcnt lgkmcnt(2)
    v_mfma_f32_32x32x16_bf16 v[56:71], v[12:15], v[8:11], 0
    ds_read_b128 v[12:15], v1 offset:34816
    v_exp_f32 v46, v46
    v_cvt_pk_bf16_f32 v42, v44, v45
    v_exp_f32 v47, v47
    v_exp_f32 v48, v48
    v_cvt_pk_bf16_f32 v43, v46, v47
    v_exp_f32 v49, v49
    v_exp_f32 v50, v50
    s_waitcnt lgkmcnt(1)
    v_mfma_f32_32x32x16_bf16 v[24:39], v[16:19], v[40:43], v[24:39]
    buffer_load_dwordx4 v[192:195], v1, s[36:39], s76 offen offset:2048 sc1
    v_cvt_pk_bf16_f32 v48, v48, v49
    v_exp_f32 v51, v51
    v_exp_f32 v52, v52
    v_cvt_pk_bf16_f32 v49, v50, v51
    v_exp_f32 v53, v53
    v_exp_f32 v54, v54
    v_exp_f32 v55, v55
    v_cvt_pk_bf16_f32 v50, v52, v53
    v_cvt_pk_bf16_f32 v51, v54, v55
    v_exp_f32 v56, v56
    v_exp_f32 v57, v57
    v_mfma_f32_32x32x16_bf16 v[24:39], v[20:23], v[48:51], v[24:39]
    s_mov_b64 exec, s[10:11]
    ds_read_b128 v[16:19], v3 offset:33792
    ds_read_b128 v[20:23], v3 offset:34304
    s_mov_b64 exec, -1
    v_exp_f32 v58, v58
    v_cvt_pk_bf16_f32 v56, v56, v57
    v_exp_f32 v59, v59
    v_exp_f32 v60, v60
    v_cvt_pk_bf16_f32 v57, v58, v59
    v_exp_f32 v61, v61
    s_waitcnt lgkmcnt(2)
    v_mfma_f32_32x32x16_bf16 v[40:55], v[12:15], v[8:11], 0
    ds_read_b128 v[12:15], v1 offset:35840
    v_exp_f32 v62, v62
    v_cvt_pk_bf16_f32 v58, v60, v61
    v_exp_f32 v63, v63
    v_exp_f32 v64, v64
    v_cvt_pk_bf16_f32 v59, v62, v63
    v_exp_f32 v65, v65
    v_exp_f32 v66, v66
    s_waitcnt lgkmcnt(1)
    v_mfma_f32_32x32x16_bf16 v[24:39], v[16:19], v[56:59], v[24:39]
    buffer_load_dwordx4 v[196:199], v1, s[36:39], s76 offen offset:3072 sc1
    s_xor_b32 s76, s76, 28672
    buffer_load_dwordx4 v[200:203], v1, s[36:39], s76 offen offset:0 sc1
    v_cvt_pk_bf16_f32 v64, v64, v65
    v_exp_f32 v67, v67
    v_exp_f32 v68, v68
    v_cvt_pk_bf16_f32 v65, v66, v67
    v_exp_f32 v69, v69
    v_exp_f32 v70, v70
    v_exp_f32 v71, v71
    v_cvt_pk_bf16_f32 v66, v68, v69
    v_cvt_pk_bf16_f32 v67, v70, v71
    v_exp_f32 v40, v40
    v_exp_f32 v41, v41
    v_mfma_f32_32x32x16_bf16 v[24:39], v[20:23], v[64:67], v[24:39]
    s_mov_b64 exec, s[10:11]
    ds_read_b128 v[16:19], v3 offset:34816
    ds_read_b128 v[20:23], v3 offset:35328
    s_mov_b64 exec, -1
    v_exp_f32 v42, v42
    v_cvt_pk_bf16_f32 v40, v40, v41
    v_exp_f32 v43, v43
    v_exp_f32 v44, v44
    v_cvt_pk_bf16_f32 v41, v42, v43
    v_exp_f32 v45, v45
    s_waitcnt lgkmcnt(2)
    v_mfma_f32_32x32x16_bf16 v[56:71], v[12:15], v[8:11], 0
    ds_read_b128 v[12:15], v1 offset:36864
    v_exp_f32 v46, v46
    v_cvt_pk_bf16_f32 v42, v44, v45
    v_exp_f32 v47, v47
    v_exp_f32 v48, v48
    v_cvt_pk_bf16_f32 v43, v46, v47
    v_exp_f32 v49, v49
    v_exp_f32 v50, v50
    s_waitcnt lgkmcnt(1)
    v_mfma_f32_32x32x16_bf16 v[24:39], v[16:19], v[40:43], v[24:39]
    buffer_load_dwordx4 v[204:207], v1, s[36:39], s76 offen offset:1024 sc1
    v_cvt_pk_bf16_f32 v48, v48, v49
    v_exp_f32 v51, v51
    v_exp_f32 v52, v52
    v_cvt_pk_bf16_f32 v49, v50, v51
    v_exp_f32 v53, v53
    v_exp_f32 v54, v54
    v_exp_f32 v55, v55
    v_cvt_pk_bf16_f32 v50, v52, v53
    v_cvt_pk_bf16_f32 v51, v54, v55
    v_exp_f32 v56, v56
    v_exp_f32 v57, v57
    v_mfma_f32_32x32x16_bf16 v[24:39], v[20:23], v[48:51], v[24:39]
    s_mov_b64 exec, s[10:11]
    ds_read_b128 v[16:19], v3 offset:35840
    ds_read_b128 v[20:23], v3 offset:36352
    s_mov_b64 exec, -1
    v_exp_f32 v58, v58
    v_cvt_pk_bf16_f32 v56, v56, v57
    v_exp_f32 v59, v59
    v_exp_f32 v60, v60
    v_cvt_pk_bf16_f32 v57, v58, v59
    v_exp_f32 v61, v61
    s_waitcnt lgkmcnt(2)
    v_mfma_f32_32x32x16_bf16 v[40:55], v[12:15], v[8:11], 0
    ds_read_b128 v[12:15], v1 offset:37888
    v_exp_f32 v62, v62
    v_cvt_pk_bf16_f32 v58, v60, v61
    v_exp_f32 v63, v63
    v_exp_f32 v64, v64
    v_cvt_pk_bf16_f32 v59, v62, v63
    v_exp_f32 v65, v65
    v_exp_f32 v66, v66
    s_waitcnt lgkmcnt(1)
    v_mfma_f32_32x32x16_bf16 v[24:39], v[16:19], v[56:59], v[24:39]
    buffer_load_dwordx4 v[208:211], v1, s[36:39], s76 offen offset:2048 sc1
    v_cvt_pk_bf16_f32 v64, v64, v65
    v_exp_f32 v67, v67
    v_exp_f32 v68, v68
    v_cvt_pk_bf16_f32 v65, v66, v67
    v_exp_f32 v69, v69
    v_exp_f32 v70, v70
    v_exp_f32 v71, v71
    v_cvt_pk_bf16_f32 v66, v68, v69
    v_cvt_pk_bf16_f32 v67, v70, v71
    v_exp_f32 v40, v40
    v_exp_f32 v41, v41
    v_mfma_f32_32x32x16_bf16 v[24:39], v[20:23], v[64:67], v[24:39]
    s_mov_b64 exec, s[10:11]
    ds_read_b128 v[16:19], v3 offset:36864
    ds_read_b128 v[20:23], v3 offset:37376
    s_mov_b64 exec, -1
    v_exp_f32 v42, v42
    v_cvt_pk_bf16_f32 v40, v40, v41
    v_exp_f32 v43, v43
    v_exp_f32 v44, v44
    v_cvt_pk_bf16_f32 v41, v42, v43
    v_exp_f32 v45, v45
    s_waitcnt lgkmcnt(2)
    v_mfma_f32_32x32x16_bf16 v[56:71], v[12:15], v[8:11], 0
    ds_read_b128 v[12:15], v1 offset:38912
    v_exp_f32 v46, v46
    v_cvt_pk_bf16_f32 v42, v44, v45
    v_exp_f32 v47, v47
    v_exp_f32 v48, v48
    v_cvt_pk_bf16_f32 v43, v46, v47
    v_exp_f32 v49, v49
    v_exp_f32 v50, v50
    s_waitcnt lgkmcnt(1)
    v_mfma_f32_32x32x16_bf16 v[24:39], v[16:19], v[40:43], v[24:39]
    buffer_load_dwordx4 v[212:215], v1, s[36:39], s76 offen offset:3072 sc1
    v_cvt_pk_bf16_f32 v48, v48, v49
    v_exp_f32 v51, v51
    v_exp_f32 v52, v52
    v_cvt_pk_bf16_f32 v49, v50, v51
    v_exp_f32 v53, v53
    v_exp_f32 v54, v54
    v_exp_f32 v55, v55
    v_cvt_pk_bf16_f32 v50, v52, v53
    v_cvt_pk_bf16_f32 v51, v54, v55
    v_exp_f32 v56, v56
    v_exp_f32 v57, v57
    v_mfma_f32_32x32x16_bf16 v[24:39], v[20:23], v[48:51], v[24:39]
    s_mov_b64 exec, s[10:11]
    ds_read_b128 v[16:19], v3 offset:37888
    ds_read_b128 v[20:23], v3 offset:38400
    s_mov_b64 exec, -1
    v_exp_f32 v58, v58
    v_cvt_pk_bf16_f32 v56, v56, v57
    v_exp_f32 v59, v59
    v_exp_f32 v60, v60
    v_cvt_pk_bf16_f32 v57, v58, v59
    v_exp_f32 v61, v61
    s_waitcnt lgkmcnt(2)
    v_mfma_f32_32x32x16_bf16 v[40:55], v[12:15], v[8:11], 0
    ds_read_b128 v[12:15], v1 offset:39936
    v_exp_f32 v62, v62
    v_cvt_pk_bf16_f32 v58, v60, v61
    v_exp_f32 v63, v63
    v_exp_f32 v64, v64
    v_cvt_pk_bf16_f32 v59, v62, v63
    v_exp_f32 v65, v65
    v_exp_f32 v66, v66
    s_waitcnt lgkmcnt(1)
    v_mfma_f32_32x32x16_bf16 v[24:39], v[16:19], v[56:59], v[24:39]
    s_xor_b32 s76, s76, 4096
    buffer_load_dwordx4 v[216:219], v1, s[36:39], s76 offen offset:0 sc1
    v_cvt_pk_bf16_f32 v64, v64, v65
    v_exp_f32 v67, v67
    v_exp_f32 v68, v68
    v_cvt_pk_bf16_f32 v65, v66, v67
    v_exp_f32 v69, v69
    v_exp_f32 v70, v70
    v_exp_f32 v71, v71
    v_cvt_pk_bf16_f32 v66, v68, v69
    v_cvt_pk_bf16_f32 v67, v70, v71
    v_exp_f32 v40, v40
    v_exp_f32 v41, v41
    v_mfma_f32_32x32x16_bf16 v[24:39], v[20:23], v[64:67], v[24:39]
    s_mov_b64 exec, s[10:11]
    ds_read_b128 v[16:19], v3 offset:38912
    ds_read_b128 v[20:23], v3 offset:39424
    s_mov_b64 exec, -1
    v_exp_f32 v42, v42
    v_cvt_pk_bf16_f32 v40, v40, v41
    v_exp_f32 v43, v43
    v_exp_f32 v44, v44
    v_cvt_pk_bf16_f32 v41, v42, v43
    v_exp_f32 v45, v45
    s_waitcnt lgkmcnt(2)
    v_mfma_f32_32x32x16_bf16 v[56:71], v[12:15], v[8:11], 0
    ds_read_b128 v[12:15], v1 offset:40960
    v_exp_f32 v46, v46
    v_cvt_pk_bf16_f32 v42, v44, v45
    v_exp_f32 v47, v47
    v_exp_f32 v48, v48
    v_cvt_pk_bf16_f32 v43, v46, v47
    v_exp_f32 v49, v49
    v_exp_f32 v50, v50
    s_waitcnt lgkmcnt(1)
    v_mfma_f32_32x32x16_bf16 v[24:39], v[16:19], v[40:43], v[24:39]
    buffer_load_dwordx4 v[220:223], v1, s[36:39], s76 offen offset:1024 sc1
    v_cvt_pk_bf16_f32 v48, v48, v49
    v_exp_f32 v51, v51
    v_exp_f32 v52, v52
    v_cvt_pk_bf16_f32 v49, v50, v51
    v_exp_f32 v53, v53
    v_exp_f32 v54, v54
    v_exp_f32 v55, v55
    v_cvt_pk_bf16_f32 v50, v52, v53
    v_cvt_pk_bf16_f32 v51, v54, v55
    v_exp_f32 v56, v56
    v_exp_f32 v57, v57
    v_mfma_f32_32x32x16_bf16 v[24:39], v[20:23], v[48:51], v[24:39]
    s_mov_b64 exec, s[10:11]
    ds_read_b128 v[16:19], v3 offset:39936
    ds_read_b128 v[20:23], v3 offset:40448
    s_mov_b64 exec, -1
    v_exp_f32 v58, v58
    v_cvt_pk_bf16_f32 v56, v56, v57
    v_exp_f32 v59, v59
    v_exp_f32 v60, v60
    v_cvt_pk_bf16_f32 v57, v58, v59
    v_exp_f32 v61, v61
    s_waitcnt lgkmcnt(2)
    v_mfma_f32_32x32x16_bf16 v[40:55], v[12:15], v[8:11], 0
    ds_read_b128 v[12:15], v1 offset:41984
    v_exp_f32 v62, v62
    v_cvt_pk_bf16_f32 v58, v60, v61
    v_exp_f32 v63, v63
    v_exp_f32 v64, v64
    v_cvt_pk_bf16_f32 v59, v62, v63
    v_exp_f32 v65, v65
    v_exp_f32 v66, v66
    s_waitcnt lgkmcnt(1)
    v_mfma_f32_32x32x16_bf16 v[24:39], v[16:19], v[56:59], v[24:39]
    buffer_load_dwordx4 v[224:227], v1, s[36:39], s76 offen offset:2048 sc1
    v_cvt_pk_bf16_f32 v64, v64, v65
    v_exp_f32 v67, v67
    v_exp_f32 v68, v68
    v_cvt_pk_bf16_f32 v65, v66, v67
    v_exp_f32 v69, v69
    v_exp_f32 v70, v70
    v_exp_f32 v71, v71
    v_cvt_pk_bf16_f32 v66, v68, v69
    v_cvt_pk_bf16_f32 v67, v70, v71
    v_exp_f32 v40, v40
    v_exp_f32 v41, v41
    v_mfma_f32_32x32x16_bf16 v[24:39], v[20:23], v[64:67], v[24:39]
    s_mov_b64 exec, s[10:11]
    ds_read_b128 v[16:19], v3 offset:40960
    ds_read_b128 v[20:23], v3 offset:41472
    s_mov_b64 exec, -1
    v_exp_f32 v42, v42
    v_cvt_pk_bf16_f32 v40, v40, v41
    v_exp_f32 v43, v43
    v_exp_f32 v44, v44
    v_cvt_pk_bf16_f32 v41, v42, v43
    v_exp_f32 v45, v45
    s_waitcnt lgkmcnt(2)
    v_mfma_f32_32x32x16_bf16 v[56:71], v[12:15], v[8:11], 0
    ds_read_b128 v[12:15], v1 offset:43008
    v_exp_f32 v46, v46
    v_cvt_pk_bf16_f32 v42, v44, v45
    v_exp_f32 v47, v47
    v_exp_f32 v48, v48
    v_cvt_pk_bf16_f32 v43, v46, v47
    v_exp_f32 v49, v49
    v_exp_f32 v50, v50
    s_waitcnt lgkmcnt(1)
    v_mfma_f32_32x32x16_bf16 v[24:39], v[16:19], v[40:43], v[24:39]
    buffer_load_dwordx4 v[228:231], v1, s[36:39], s76 offen offset:3072 sc1
    s_xor_b32 s76, s76, 12288
    buffer_load_dwordx4 v[232:235], v1, s[36:39], s76 offen offset:0 sc1
    v_cvt_pk_bf16_f32 v48, v48, v49
    v_exp_f32 v51, v51
    v_exp_f32 v52, v52
    v_cvt_pk_bf16_f32 v49, v50, v51
    v_exp_f32 v53, v53
    v_exp_f32 v54, v54
    v_exp_f32 v55, v55
    v_cvt_pk_bf16_f32 v50, v52, v53
    v_cvt_pk_bf16_f32 v51, v54, v55
    v_exp_f32 v56, v56
    v_exp_f32 v57, v57
    v_mfma_f32_32x32x16_bf16 v[24:39], v[20:23], v[48:51], v[24:39]
    s_mov_b64 exec, s[10:11]
    ds_read_b128 v[16:19], v3 offset:41984
    ds_read_b128 v[20:23], v3 offset:42496
    s_mov_b64 exec, -1
    v_exp_f32 v58, v58
    v_cvt_pk_bf16_f32 v56, v56, v57
    v_exp_f32 v59, v59
    v_exp_f32 v60, v60
    v_cvt_pk_bf16_f32 v57, v58, v59
    v_exp_f32 v61, v61
    s_waitcnt lgkmcnt(2)
    v_mfma_f32_32x32x16_bf16 v[40:55], v[12:15], v[8:11], 0
    ds_read_b128 v[12:15], v1 offset:44032
    v_exp_f32 v62, v62
    v_cvt_pk_bf16_f32 v58, v60, v61
    v_exp_f32 v63, v63
    v_exp_f32 v64, v64
    v_cvt_pk_bf16_f32 v59, v62, v63
    v_exp_f32 v65, v65
    v_exp_f32 v66, v66
    s_waitcnt lgkmcnt(1)
    v_mfma_f32_32x32x16_bf16 v[24:39], v[16:19], v[56:59], v[24:39]
    buffer_load_dwordx4 v[236:239], v1, s[36:39], s76 offen offset:1024 sc1
    s_lshl_b32 s48, s87, 3
    s_add_u32 s48, s48, s19
    s_lshl_b32 s24, s87, 14
    s_add_u32 s24, s24, 12582912
    s_mul_i32 s28, s48, 28672
    s_add_u32 s28, s28, 13631488
    s_mov_b32 s29, s28
    v_cvt_pk_bf16_f32 v64, v64, v65
    v_exp_f32 v67, v67
    v_exp_f32 v68, v68
    v_cvt_pk_bf16_f32 v65, v66, v67
    v_exp_f32 v69, v69
    v_exp_f32 v70, v70
    v_exp_f32 v71, v71
    v_cvt_pk_bf16_f32 v66, v68, v69
    v_cvt_pk_bf16_f32 v67, v70, v71
    v_exp_f32 v40, v40
    v_exp_f32 v41, v41
    v_mfma_f32_32x32x16_bf16 v[24:39], v[20:23], v[64:67], v[24:39]
    s_mov_b64 exec, s[10:11]
    ds_read_b128 v[16:19], v3 offset:43008
    ds_read_b128 v[20:23], v3 offset:43520
    s_mov_b64 exec, -1
    v_exp_f32 v42, v42
    v_cvt_pk_bf16_f32 v40, v40, v41
    v_exp_f32 v43, v43
    v_exp_f32 v44, v44
    v_cvt_pk_bf16_f32 v41, v42, v43
    v_exp_f32 v45, v45
    s_waitcnt lgkmcnt(2)
    v_mfma_f32_32x32x16_bf16 v[56:71], v[12:15], v[8:11], 0
    ds_read_b128 v[12:15], v1 offset:45056
    v_exp_f32 v46, v46
    v_cvt_pk_bf16_f32 v42, v44, v45
    v_exp_f32 v47, v47
    v_exp_f32 v48, v48
    v_cvt_pk_bf16_f32 v43, v46, v47
    v_exp_f32 v49, v49
    v_exp_f32 v50, v50
    s_waitcnt lgkmcnt(1)
    v_mfma_f32_32x32x16_bf16 v[24:39], v[16:19], v[40:43], v[24:39]
    buffer_load_dwordx4 v[240:243], v1, s[36:39], s76 offen offset:2048 sc1
    s_lshl_b32 s27, s19, 12
    s_lshl_b32 s26, s87, 16
    s_add_u32 s26, s26, 8388608
    s_add_u32 s25, s26, s27
    s_add_u32 s26, s26, 32768
    s_add_u32 s17, s89, 32768
    v_cvt_pk_bf16_f32 v48, v48, v49
    v_exp_f32 v51, v51
    v_exp_f32 v52, v52
    v_cvt_pk_bf16_f32 v49, v50, v51
    v_exp_f32 v53, v53
    v_exp_f32 v54, v54
    v_exp_f32 v55, v55
    v_cvt_pk_bf16_f32 v50, v52, v53
    v_cvt_pk_bf16_f32 v51, v54, v55
    v_exp_f32 v56, v56
    v_exp_f32 v57, v57
    v_mfma_f32_32x32x16_bf16 v[24:39], v[20:23], v[48:51], v[24:39]
    s_mov_b64 exec, s[10:11]
    ds_read_b128 v[16:19], v3 offset:44032
    ds_read_b128 v[20:23], v3 offset:44544
    s_mov_b64 exec, -1
    v_exp_f32 v58, v58
    v_cvt_pk_bf16_f32 v56, v56, v57
    v_exp_f32 v59, v59
    v_exp_f32 v60, v60
    v_cvt_pk_bf16_f32 v57, v58, v59
    v_exp_f32 v61, v61
    s_waitcnt lgkmcnt(2)
    v_mfma_f32_32x32x16_bf16 v[40:55], v[12:15], v[8:11], 0
    ds_read_b128 v[12:15], v1 offset:46080
    v_exp_f32 v62, v62
    v_cvt_pk_bf16_f32 v58, v60, v61
    v_exp_f32 v63, v63
    v_exp_f32 v64, v64
    v_cvt_pk_bf16_f32 v59, v62, v63
    v_exp_f32 v65, v65
    v_exp_f32 v66, v66
    s_waitcnt lgkmcnt(1)
    v_mfma_f32_32x32x16_bf16 v[24:39], v[16:19], v[56:59], v[24:39]
    buffer_load_dwordx4 v[244:247], v1, s[36:39], s76 offen offset:3072 sc1
    s_lshl_b32 s30, s87, 16
    s_lshl_b32 s31, s85, 12
    s_add_u32 s31, s31, s30
    s_lshl_b32 s48, s85, 7
    s_add_u32 s30, s30, s48
    s_lshl_b32 s48, s5, 11
    s_add_u32 s30, s30, s48
    s_lshl_b32 s48, s5, 5
    s_add_u32 s31, s31, s48
    s_add_u32 s31, s31, 10485760
    s_add_u32 s18, s31, 32768
    v_cvt_pk_bf16_f32 v64, v64, v65
    v_exp_f32 v67, v67
    v_exp_f32 v68, v68
    v_cvt_pk_bf16_f32 v65, v66, v67
    v_exp_f32 v69, v69
    v_exp_f32 v70, v70
    v_exp_f32 v71, v71
    v_cvt_pk_bf16_f32 v66, v68, v69
    v_cvt_pk_bf16_f32 v67, v70, v71
    v_exp_f32 v40, v40
    v_exp_f32 v41, v41
    v_mfma_f32_32x32x16_bf16 v[24:39], v[20:23], v[64:67], v[24:39]
    s_mov_b64 exec, s[10:11]
    ds_read_b128 v[16:19], v3 offset:45056
    ds_read_b128 v[20:23], v3 offset:45568
    s_mov_b64 exec, -1
    v_exp_f32 v42, v42
    v_cvt_pk_bf16_f32 v40, v40, v41
    v_exp_f32 v43, v43
    v_exp_f32 v44, v44
    v_cvt_pk_bf16_f32 v41, v42, v43
    v_exp_f32 v45, v45
    s_waitcnt lgkmcnt(2)
    v_mfma_f32_32x32x16_bf16 v[56:71], v[12:15], v[8:11], 0
    ds_read_b128 v[12:15], v1 offset:47104
    v_exp_f32 v46, v46
    v_cvt_pk_bf16_f32 v42, v44, v45
    v_exp_f32 v47, v47
    v_exp_f32 v48, v48
    v_cvt_pk_bf16_f32 v43, v46, v47
    v_exp_f32 v49, v49
    v_exp_f32 v50, v50
    s_waitcnt lgkmcnt(1)
    v_mfma_f32_32x32x16_bf16 v[24:39], v[16:19], v[40:43], v[24:39]
    s_xor_b32 s76, s76, 4096
    buffer_load_dwordx4 v[248:251], v1, s[36:39], s76 offen offset:0 sc1
    s_lshl_b32 s91, s86, 5
    s_lshl_b32 s48, s43, 1
    s_xor_b32 s48, s48, s5
    s_lshl_b32 s48, s48, 2
    s_add_u32 s91, s91, s48
    s_lshl_b32 s91, s91, 10
    s_add_u32 s91, s91, 6291456
    s_mov_b32 s78, 1454080
    buffer_load_dwordx4 v[112:115], v1, s[36:39], s78 offen offset:0 sc1
    buffer_load_dwordx4 v[116:119], v1, s[36:39], s78 offen offset:1024 sc1
    v_cvt_pk_bf16_f32 v48, v48, v49
    v_exp_f32 v51, v51
    v_exp_f32 v52, v52
    v_cvt_pk_bf16_f32 v49, v50, v51
    v_exp_f32 v53, v53
    v_exp_f32 v54, v54
    v_exp_f32 v55, v55
    v_cvt_pk_bf16_f32 v50, v52, v53
    v_cvt_pk_bf16_f32 v51, v54, v55
    v_exp_f32 v56, v56
    v_exp_f32 v57, v57
    v_mfma_f32_32x32x16_bf16 v[24:39], v[20:23], v[48:51], v[24:39]
    s_mov_b64 exec, s[10:11]
    ds_read_b128 v[16:19], v3 offset:46080
    ds_read_b128 v[20:23], v3 offset:46592
    s_mov_b64 exec, -1
    v_exp_f32 v58, v58
    v_cvt_pk_bf16_f32 v56, v56, v57
    v_exp_f32 v59, v59
    v_exp_f32 v60, v60
    v_cvt_pk_bf16_f32 v57, v58, v59
    v_exp_f32 v61, v61
    s_waitcnt lgkmcnt(2)
    v_mfma_f32_32x32x16_bf16 v[40:55], v[12:15], v[8:11], 0
    ds_read_b128 v[12:15], v1 offset:48128
    v_exp_f32 v62, v62
    v_cvt_pk_bf16_f32 v58, v60, v61
    v_exp_f32 v63, v63
    v_exp_f32 v64, v64
    v_cvt_pk_bf16_f32 v59, v62, v63
    v_exp_f32 v65, v65
    v_exp_f32 v66, v66
    s_waitcnt lgkmcnt(1)
    v_mfma_f32_32x32x16_bf16 v[24:39], v[16:19], v[56:59], v[24:39]
    buffer_load_dwordx4 v[252:255], v1, s[36:39], s76 offen offset:1024 sc1
    v_cvt_pk_bf16_f32 v64, v64, v65
    v_exp_f32 v67, v67
    v_exp_f32 v68, v68
    v_cvt_pk_bf16_f32 v65, v66, v67
    v_exp_f32 v69, v69
    v_exp_f32 v70, v70
    v_exp_f32 v71, v71
    v_cvt_pk_bf16_f32 v66, v68, v69
    v_cvt_pk_bf16_f32 v67, v70, v71
    v_exp_f32 v40, v40
    v_exp_f32 v41, v41
    v_mfma_f32_32x32x16_bf16 v[24:39], v[20:23], v[64:67], v[24:39]
    s_mov_b64 exec, s[10:11]
    ds_read_b128 v[16:19], v3 offset:47104
    ds_read_b128 v[20:23], v3 offset:47616
    s_mov_b64 exec, -1
    v_exp_f32 v42, v42
    v_cvt_pk_bf16_f32 v40, v40, v41
    v_exp_f32 v43, v43
    v_exp_f32 v44, v44
    v_cvt_pk_bf16_f32 v41, v42, v43
    v_exp_f32 v45, v45
    s_waitcnt lgkmcnt(2)
    v_mfma_f32_32x32x16_bf16 v[56:71], v[12:15], v[8:11], 0
    ds_read_b128 v[12:15], v1 offset:49152
    v_exp_f32 v46, v46
    v_cvt_pk_bf16_f32 v42, v44, v45
    v_exp_f32 v47, v47
    v_exp_f32 v48, v48
    v_cvt_pk_bf16_f32 v43, v46, v47
    v_exp_f32 v49, v49
    v_exp_f32 v50, v50
    s_waitcnt lgkmcnt(1)
    v_mfma_f32_32x32x16_bf16 v[24:39], v[16:19], v[40:43], v[24:39]
    buffer_load_dwordx4 v[72:75], v1, s[36:39], s77 offen offset:0 sc1
    buffer_load_dwordx4 v[76:79], v1, s[36:39], s77 offen offset:1024 sc1
    v_cvt_pk_bf16_f32 v48, v48, v49
    v_exp_f32 v51, v51
    v_exp_f32 v52, v52
    v_cvt_pk_bf16_f32 v49, v50, v51
    v_exp_f32 v53, v53
    v_exp_f32 v54, v54
    v_exp_f32 v55, v55
    v_cvt_pk_bf16_f32 v50, v52, v53
    v_cvt_pk_bf16_f32 v51, v54, v55
    s_setprio 2
    v_exp_f32 v56, v56
    v_exp_f32 v57, v57
    v_mfma_f32_32x32x16_bf16 v[24:39], v[20:23], v[48:51], v[24:39]
    s_mov_b64 exec, s[10:11]
    ds_read_b128 v[16:19], v3 offset:48128
    ds_read_b128 v[20:23], v3 offset:48640
    s_mov_b64 exec, -1
    v_exp_f32 v58, v58
    v_cvt_pk_bf16_f32 v56, v56, v57
    v_exp_f32 v59, v59
    v_exp_f32 v60, v60
    v_cvt_pk_bf16_f32 v57, v58, v59
    v_exp_f32 v61, v61
    s_waitcnt lgkmcnt(2)
    v_mfma_f32_32x32x16_bf16 v[40:55], v[12:15], v[8:11], 0
    ds_read_b128 v[12:15], v1 offset:50176
    v_exp_f32 v62, v62
    v_cvt_pk_bf16_f32 v58, v60, v61
    v_exp_f32 v63, v63
    v_exp_f32 v64, v64
    v_cvt_pk_bf16_f32 v59, v62, v63
    v_exp_f32 v65, v65
    v_exp_f32 v66, v66
    s_waitcnt lgkmcnt(1)
    v_mfma_f32_32x32x16_bf16 v[24:39], v[16:19], v[56:59], v[24:39]
    buffer_load_dwordx4 v[80:83], v1, s[36:39], s77 offen offset:2048 sc1
    s_mov_b32 m0, s89
    s_nop 0
    buffer_load_dwordx4 v1, s[36:39], s76 offen offset:2048 sc1 lds
    buffer_load_dwordx4 v1, s[36:39], s76 offen offset:3072 sc1 lds
    v_cvt_pk_bf16_f32 v64, v64, v65
    v_exp_f32 v67, v67
    v_exp_f32 v68, v68
    v_cvt_pk_bf16_f32 v65, v66, v67
    v_exp_f32 v69, v69
    v_exp_f32 v70, v70
    v_exp_f32 v71, v71
    v_cvt_pk_bf16_f32 v66, v68, v69
    v_cvt_pk_bf16_f32 v67, v70, v71
    v_exp_f32 v40, v40
    v_exp_f32 v41, v41
    v_mfma_f32_32x32x16_bf16 v[24:39], v[20:23], v[64:67], v[24:39]
    s_mov_b64 exec, s[10:11]
    ds_read_b128 v[16:19], v3 offset:49152
    ds_read_b128 v[20:23], v3 offset:49664
    s_mov_b64 exec, -1
    v_exp_f32 v42, v42
    v_cvt_pk_bf16_f32 v40, v40, v41
    v_exp_f32 v43, v43
    v_exp_f32 v44, v44
    v_cvt_pk_bf16_f32 v41, v42, v43
    v_exp_f32 v45, v45
    s_waitcnt lgkmcnt(2)
    v_mfma_f32_32x32x16_bf16 v[56:71], v[12:15], v[8:11], 0
    ds_read_b128 v[12:15], v1 offset:51200
    v_exp_f32 v46, v46
    v_cvt_pk_bf16_f32 v42, v44, v45
    v_exp_f32 v47, v47
    v_exp_f32 v48, v48
    v_cvt_pk_bf16_f32 v43, v46, v47
    v_exp_f32 v49, v49
    v_exp_f32 v50, v50
    s_waitcnt lgkmcnt(1)
    v_mfma_f32_32x32x16_bf16 v[24:39], v[16:19], v[40:43], v[24:39]
    buffer_load_dwordx4 v[84:87], v1, s[36:39], s77 offen offset:3072 sc1
    s_waitcnt vmcnt(7)
L_chk_75:
    v_cmp_ne_u64 vcc, s[6:7], v[112:113]
    v_cmp_ne_u64 s[50:51], s[6:7], v[114:115]
    v_cmp_ne_u64 s[52:53], s[6:7], v[116:117]
    v_cmp_ne_u64 s[54:55], s[6:7], v[118:119]
    s_or_b64 vcc, vcc, s[50:51]
    s_or_b64 s[52:53], s[52:53], s[54:55]
    s_or_b64 vcc, vcc, s[52:53]
    s_cbranch_scc1 L_rty_76
L_ok_77:
    v_cvt_pk_bf16_f32 v48, v48, v49
    v_exp_f32 v51, v51
    v_exp_f32 v52, v52
    v_cvt_pk_bf16_f32 v49, v50, v51
    v_exp_f32 v53, v53
    v_exp_f32 v54, v54
    v_exp_f32 v55, v55
    v_cvt_pk_bf16_f32 v50, v52, v53
    v_cvt_pk_bf16_f32 v51, v54, v55
    v_exp_f32 v56, v56
    v_exp_f32 v57, v57
    v_mfma_f32_32x32x16_bf16 v[24:39], v[20:23], v[48:51], v[24:39]
    s_mov_b64 exec, s[10:11]
    ds_read_b128 v[16:19], v3 offset:50176
    ds_read_b128 v[20:23], v3 offset:50688
    s_mov_b64 exec, -1
    v_exp_f32 v58, v58
    v_cvt_pk_bf16_f32 v56, v56, v57
    v_exp_f32 v59, v59
    v_exp_f32 v60, v60
    v_cvt_pk_bf16_f32 v57, v58, v59
    v_exp_f32 v61, v61
    s_waitcnt lgkmcnt(2)
    v_mfma_f32_32x32x16_bf16 v[40:55], v[12:15], v[8:11], 0
    ds_read_b128 v[12:15], v1 offset:52224
    v_exp_f32 v62, v62
    v_cvt_pk_bf16_f32 v58, v60, v61
    v_exp_f32 v63, v63
    v_exp_f32 v64, v64
    v_cvt_pk_bf16_f32 v59, v62, v63
    v_exp_f32 v65, v65
    v_exp_f32 v66, v66
    s_waitcnt lgkmcnt(1)
    v_mfma_f32_32x32x16_bf16 v[24:39], v[16:19], v[56:59], v[24:39]
    s_xor_b32 s77, s77, 4096
    buffer_load_dwordx4 v[88:91], v1, s[36:39], s77 offen offset:0 sc1
    v_cvt_pk_bf16_f32 v64, v64, v65
    v_exp_f32 v67, v67
    v_exp_f32 v68, v68
    v_cvt_pk_bf16_f32 v65, v66, v67
    v_exp_f32 v69, v69
    v_exp_f32 v70, v70
    v_exp_f32 v71, v71
    v_cvt_pk_bf16_f32 v66, v68, v69
    v_cvt_pk_bf16_f32 v67, v70, v71
    v_exp_f32 v40, v40
    v_exp_f32 v41, v41
    v_mfma_f32_32x32x16_bf16 v[24:39], v[20:23], v[64:67], v[24:39]
    s_mov_b64 exec, s[10:11]
    ds_read_b128 v[16:19], v3 offset:51200
    ds_read_b128 v[20:23], v3 offset:51712
    s_mov_b64 exec, -1
    v_exp_f32 v42, v42
    v_cvt_pk_bf16_f32 v40, v40, v41
    v_exp_f32 v43, v43
    v_exp_f32 v44, v44
    v_cvt_pk_bf16_f32 v41, v42, v43
    v_exp_f32 v45, v45
    s_waitcnt lgkmcnt(2)
    v_mfma_f32_32x32x16_bf16 v[56:71], v[12:15], v[8:11], 0
    ds_read_b128 v[12:15], v1 offset:53248
    v_exp_f32 v46, v46
    v_cvt_pk_bf16_f32 v42, v44, v45
    v_exp_f32 v47, v47
    v_exp_f32 v48, v48
    v_cvt_pk_bf16_f32 v43, v46, v47
    v_exp_f32 v49, v49
    v_exp_f32 v50, v50
    s_waitcnt lgkmcnt(1)
    v_mfma_f32_32x32x16_bf16 v[24:39], v[16:19], v[40:43], v[24:39]
    buffer_load_dwordx4 v[92:95], v1, s[36:39], s77 offen offset:1024 sc1
    v_cvt_pk_bf16_f32 v48, v48, v49
    v_exp_f32 v51, v51
    v_exp_f32 v52, v52
    v_cvt_pk_bf16_f32 v49, v50, v51
    v_exp_f32 v53, v53
    v_exp_f32 v54, v54
    v_exp_f32 v55, v55
    v_cvt_pk_bf16_f32 v50, v52, v53
    v_cvt_pk_bf16_f32 v51, v54, v55
    v_exp_f32 v56, v56
    v_exp_f32 v57, v57
    v_mfma_f32_32x32x16_bf16 v[24:39], v[20:23], v[48:51], v[24:39]
    s_mov_b64 exec, s[10:11]
    ds_read_b128 v[16:19], v3 offset:52224
    ds_read_b128 v[20:23], v3 offset:52736
    s_mov_b64 exec, -1
    v_exp_f32 v58, v58
    v_cvt_pk_bf16_f32 v56, v56, v57
    v_exp_f32 v59, v59
    v_exp_f32 v60, v60
    v_cvt_pk_bf16_f32 v57, v58, v59
    v_exp_f32 v61, v61
    s_waitcnt lgkmcnt(2)
    v_mfma_f32_32x32x16_bf16 v[40:55], v[12:15], v[8:11], 0
    ds_read_b128 v[12:15], v1 offset:54272
    v_exp_f32 v62, v62
    v_cvt_pk_bf16_f32 v58, v60, v61
    v_exp_f32 v63, v63
    v_exp_f32 v64, v64
    v_cvt_pk_bf16_f32 v59, v62, v63
    v_exp_f32 v65, v65
    v_exp_f32 v66, v66
    s_waitcnt lgkmcnt(1)
    v_mfma_f32_32x32x16_bf16 v[24:39], v[16:19], v[56:59], v[24:39]
    buffer_load_dwordx4 v[96:99], v1, s[36:39], s77 offen offset:2048 sc1
    v_cvt_pk_bf16_f32 v64, v64, v65
    v_exp_f32 v67, v67
    v_exp_f32 v68, v68
    v_cvt_pk_bf16_f32 v65, v66, v67
    v_exp_f32 v69, v69
    v_exp_f32 v70, v70
    v_exp_f32 v71, v71
    v_cvt_pk_bf16_f32 v66, v68, v69
    v_cvt_pk_bf16_f32 v67, v70, v71
    v_exp_f32 v40, v40
    v_exp_f32 v41, v41
    v_mfma_f32_32x32x16_bf16 v[24:39], v[20:23], v[64:67], v[24:39]
    s_mov_b64 exec, s[10:11]
    ds_read_b128 v[16:19], v3 offset:53248
    ds_read_b128 v[20:23], v3 offset:53760
    s_mov_b64 exec, -1
    v_exp_f32 v42, v42
    v_cvt_pk_bf16_f32 v40, v40, v41
    v_exp_f32 v43, v43
    v_exp_f32 v44, v44
    v_cvt_pk_bf16_f32 v41, v42, v43
    v_exp_f32 v45, v45
    s_waitcnt lgkmcnt(2)
    v_mfma_f32_32x32x16_bf16 v[56:71], v[12:15], v[8:11], 0
    ds_read_b128 v[12:15], v1 offset:55296
    v_exp_f32 v46, v46
    v_cvt_pk_bf16_f32 v42, v44, v45
    v_exp_f32 v47, v47
    v_exp_f32 v48, v48
    v_cvt_pk_bf16_f32 v43, v46, v47
    v_exp_f32 v49, v49
    v_exp_f32 v50, v50
    s_waitcnt lgkmcnt(1)
    v_mfma_f32_32x32x16_bf16 v[24:39], v[16:19], v[40:43], v[24:39]
    buffer_load_dwordx4 v[100:103], v1, s[36:39], s77 offen offset:3072 sc1
    v_cvt_pk_bf16_f32 v48, v48, v49
    v_exp_f32 v51, v51
    v_exp_f32 v52, v52
    v_cvt_pk_bf16_f32 v49, v50, v51
    v_exp_f32 v53, v53
    v_exp_f32 v54, v54
    v_exp_f32 v55, v55
    v_cvt_pk_bf16_f32 v50, v52, v53
    v_cvt_pk_bf16_f32 v51, v54, v55
    v_exp_f32 v56, v56
    v_exp_f32 v57, v57
    v_mfma_f32_32x32x16_bf16 v[24:39], v[20:23], v[48:51], v[24:39]
    s_mov_b64 exec, s[10:11]
    ds_read_b128 v[16:19], v3 offset:54272
    ds_read_b128 v[20:23], v3 offset:54784
    s_mov_b64 exec, -1
    v_exp_f32 v58, v58
    v_cvt_pk_bf16_f32 v56, v56, v57
    v_exp_f32 v59, v59
    v_exp_f32 v60, v60
    v_cvt_pk_bf16_f32 v57, v58, v59
    v_exp_f32 v61, v61
    s_waitcnt lgkmcnt(2)
    v_mfma_f32_32x32x16_bf16 v[40:55], v[12:15], v[8:11], 0
    ds_read_b128 v[12:15], v1 offset:56320
    v_exp_f32 v62, v62
    v_cvt_pk_bf16_f32 v58, v60, v61
    v_exp_f32 v63, v63
    v_exp_f32 v64, v64
    v_cvt_pk_bf16_f32 v59, v62, v63
    v_exp_f32 v65, v65
    v_exp_f32 v66, v66
    s_waitcnt lgkmcnt(1)
    v_mfma_f32_32x32x16_bf16 v[24:39], v[16:19], v[56:59], v[24:39]
    s_xor_b32 s77, s77, 12288
    buffer_load_dwordx4 v[104:107], v1, s[36:39], s77 offen offset:0 sc1
    buffer_load_dwordx4 v[108:111], v1, s[36:39], s77 offen offset:1024 sc1
    v_cvt_pk_bf16_f32 v64, v64, v65
    v_exp_f32 v67, v67
    v_exp_f32 v68, v68
    v_cvt_pk_bf16_f32 v65, v66, v67
    v_exp_f32 v69, v69
    v_exp_f32 v70, v70
    v_exp_f32 v71, v71
    v_cvt_pk_bf16_f32 v66, v68, v69
    v_cvt_pk_bf16_f32 v67, v70, v71
    v_exp_f32 v40, v40
    v_exp_f32 v41, v41
    v_mfma_f32_32x32x16_bf16 v[24:39], v[20:23], v[64:67], v[24:39]
    s_mov_b64 exec, s[10:11]
    ds_read_b128 v[16:19], v3 offset:55296
    ds_read_b128 v[20:23], v3 offset:55808
    s_mov_b64 exec, -1
    v_exp_f32 v42, v42
    v_cvt_pk_bf16_f32 v40, v40, v41
    v_exp_f32 v43, v43
    v_exp_f32 v44, v44
    v_cvt_pk_bf16_f32 v41, v42, v43
    v_exp_f32 v45, v45
    s_waitcnt lgkmcnt(2)
    v_mfma_f32_32x32x16_bf16 v[56:71], v[12:15], v[8:11], 0
    ds_read_b128 v[12:15], v1 offset:57344
    v_exp_f32 v46, v46
    v_cvt_pk_bf16_f32 v42, v44, v45
    v_exp_f32 v47, v47
    v_exp_f32 v48, v48
    v_cvt_pk_bf16_f32 v43, v46, v47
    v_exp_f32 v49, v49
    v_exp_f32 v50, v50
    s_waitcnt lgkmcnt(1)
    v_mfma_f32_32x32x16_bf16 v[24:39], v[16:19], v[40:43], v[24:39]
    buffer_load_dwordx4 v[112:115], v1, s[36:39], s77 offen offset:2048 sc1
    v_cvt_pk_bf16_f32 v48, v48, v49
    v_exp_f32 v51, v51
    v_exp_f32 v52, v52
    v_cvt_pk_bf16_f32 v49, v50, v51
    v_exp_f32 v53, v53
    v_exp_f32 v54, v54
    v_exp_f32 v55, v55
    v_cvt_pk_bf16_f32 v50, v52, v53
    v_cvt_pk_bf16_f32 v51, v54, v55
    v_exp_f32 v56, v56
    v_exp_f32 v57, v57
    v_mfma_f32_32x32x16_bf16 v[24:39], v[20:23], v[48:51], v[24:39]
    s_mov_b64 exec, s[10:11]
    ds_read_b128 v[16:19], v3 offset:56320
    ds_read_b128 v[20:23], v3 offset:56832
    s_mov_b64 exec, -1
    v_exp_f32 v58, v58
    v_cvt_pk_bf16_f32 v56, v56, v57
    v_exp_f32 v59, v59
    v_exp_f32 v60, v60
    v_cvt_pk_bf16_f32 v57, v58, v59
    v_exp_f32 v61, v61
    s_waitcnt lgkmcnt(2)
    v_mfma_f32_32x32x16_bf16 v[40:55], v[12:15], v[8:11], 0
    ds_read_b128 v[12:15], v1 offset:58368
    v_exp_f32 v62, v62
    v_cvt_pk_bf16_f32 v58, v60, v61
    v_exp_f32 v63, v63
    v_exp_f32 v64, v64
    v_cvt_pk_bf16_f32 v59, v62, v63
    v_exp_f32 v65, v65
    v_exp_f32 v66, v66
    s_waitcnt lgkmcnt(1)
    v_mfma_f32_32x32x16_bf16 v[24:39], v[16:19], v[56:59], v[24:39]
    buffer_load_dwordx4 v[116:119], v1, s[36:39], s77 offen offset:3072 sc1
    v_cvt_pk_bf16_f32 v64, v64, v65
    v_exp_f32 v67, v67
    v_exp_f32 v68, v68
    v_cvt_pk_bf16_f32 v65, v66, v67
    v_exp_f32 v69, v69
    v_exp_f32 v70, v70
    v_exp_f32 v71, v71
    v_cvt_pk_bf16_f32 v66, v68, v69
    v_cvt_pk_bf16_f32 v67, v70, v71
    v_exp_f32 v40, v40
    v_exp_f32 v41, v41
    v_mfma_f32_32x32x16_bf16 v[24:39], v[20:23], v[64:67], v[24:39]
    s_mov_b64 exec, s[10:11]
    ds_read_b128 v[16:19], v3 offset:57344
    ds_read_b128 v[20:23], v3 offset:57856
    s_mov_b64 exec, -1
    v_exp_f32 v42, v42
    v_cvt_pk_bf16_f32 v40, v40, v41
    v_exp_f32 v43, v43
    v_exp_f32 v44, v44
    v_cvt_pk_bf16_f32 v41, v42, v43
    v_exp_f32 v45, v45
    s_waitcnt lgkmcnt(2)
    v_mfma_f32_32x32x16_bf16 v[56:71], v[12:15], v[8:11], 0
    ds_read_b128 v[12:15], v1 offset:59392
    v_exp_f32 v46, v46
    v_cvt_pk_bf16_f32 v42, v44, v45
    v_exp_f32 v47, v47
    v_exp_f32 v48, v48
    v_cvt_pk_bf16_f32 v43, v46, v47
    v_exp_f32 v49, v49
    v_exp_f32 v50, v50
    s_waitcnt lgkmcnt(1)
    v_mfma_f32_32x32x16_bf16 v[24:39], v[16:19], v[40:43], v[24:39]
    s_xor_b32 s77, s77, 4096
    buffer_load_dwordx4 v[120:123], v1, s[36:39], s77 offen offset:0 sc1
    v_cvt_pk_bf16_f32 v48, v48, v49
    v_exp_f32 v51, v51
    v_exp_f32 v52, v52
    v_cvt_pk_bf16_f32 v49, v50, v51
    v_exp_f32 v53, v53
    v_exp_f32 v54, v54
    v_exp_f32 v55, v55
    v_cvt_pk_bf16_f32 v50, v52, v53
    v_cvt_pk_bf16_f32 v51, v54, v55
    s_setprio 1
    v_exp_f32 v56, v56
    v_exp_f32 v57, v57
    v_mfma_f32_32x32x16_bf16 v[24:39], v[20:23], v[48:51], v[24:39]
    s_mov_b64 exec, s[10:11]
    ds_read_b128 v[16:19], v3 offset:58368
    ds_read_b128 v[20:23], v3 offset:58880
    s_mov_b64 exec, -1
    v_exp_f32 v58, v58
    v_cvt_pk_bf16_f32 v56, v56, v57
    v_exp_f32 v59, v59
    v_exp_f32 v60, v60
    v_cvt_pk_bf16_f32 v57, v58, v59
    v_exp_f32 v61, v61
    s_waitcnt lgkmcnt(2)
    v_mfma_f32_32x32x16_bf16 v[40:55], v[12:15], v[8:11], 0
    ds_read_b128 v[12:15], v1 offset:60416
    v_exp_f32 v62, v62
    v_cvt_pk_bf16_f32 v58, v60, v61
    v_exp_f32 v63, v63
    v_exp_f32 v64, v64
    v_cvt_pk_bf16_f32 v59, v62, v63
    v_exp_f32 v65, v65
    v_exp_f32 v66, v66
    s_waitcnt lgkmcnt(1)
    v_mfma_f32_32x32x16_bf16 v[24:39], v[16:19], v[56:59], v[24:39]
    buffer_load_dwordx4 v[124:127], v1, s[36:39], s77 offen offset:1024 sc1
    s_cmp_eq_u32 s5, 7
    s_cbranch_scc1 L_nosa_78
    s_add_u32 s48, s79, 2048
    s_add_u32 m0, s88, 0
    s_nop 0
    buffer_load_dwordx4 v1, s[36:39], s48 offen offset:0 sc1 lds
    buffer_load_dwordx4 v1, s[36:39], s48 offen offset:1024 sc1 lds
L_nosa_78:
    v_cvt_pk_bf16_f32 v64, v64, v65
    v_exp_f32 v67, v67
    v_exp_f32 v68, v68
    v_cvt_pk_bf16_f32 v65, v66, v67
    v_exp_f32 v69, v69
    v_exp_f32 v70, v70
    v_exp_f32 v71, v71
    v_cvt_pk_bf16_f32 v66, v68, v69
    v_cvt_pk_bf16_f32 v67, v70, v71
    v_exp_f32 v40, v40
    v_exp_f32 v41, v41
    v_mfma_f32_32x32x16_bf16 v[24:39], v[20:23], v[64:67], v[24:39]
    s_mov_b64 exec, s[10:11]
    ds_read_b128 v[16:19], v3 offset:59392
    ds_read_b128 v[20:23], v3 offset:59904
    s_mov_b64 exec, -1
    v_exp_f32 v42, v42
    v_cvt_pk_bf16_f32 v40, v40, v41
    v_exp_f32 v43, v43
    v_exp_f32 v44, v44
    v_cvt_pk_bf16_f32 v41, v42, v43
    v_exp_f32 v45, v45
    s_waitcnt lgkmcnt(2)
    v_mfma_f32_32x32x16_bf16 v[56:71], v[12:15], v[8:11], 0
    ds_read_b128 v[12:15], v1 offset:61440
    v_exp_f32 v46, v46
    v_cvt_pk_bf16_f32 v42, v44, v45
    v_exp_f32 v47, v47
    v_exp_f32 v48, v48
    v_cvt_pk_bf16_f32 v43, v46, v47
    v_exp_f32 v49, v49
    v_exp_f32 v50, v50
    s_waitcnt lgkmcnt(1)
    v_mfma_f32_32x32x16_bf16 v[24:39], v[16:19], v[40:43], v[24:39]
    buffer_load_dwordx4 v[128:131], v1, s[36:39], s77 offen offset:2048 sc1
    v_cvt_pk_bf16_f32 v48, v48, v49
    v_exp_f32 v51, v51
    v_exp_f32 v52, v52
    v_cvt_pk_bf16_f32 v49, v50, v51
    v_exp_f32 v53, v53
    v_exp_f32 v54, v54
    v_exp_f32 v55, v55
    v_cvt_pk_bf16_f32 v50, v52, v53
    v_cvt_pk_bf16_f32 v51, v54, v55
    v_exp_f32 v56, v56
    v_exp_f32 v57, v57
    v_mfma_f32_32x32x16_bf16 v[24:39], v[20:23], v[48:51], v[24:39]
    s_mov_b64 exec, s[10:11]
    ds_read_b128 v[16:19], v3 offset:60416
    ds_read_b128 v[20:23], v3 offset:60928
    s_mov_b64 exec, -1
    v_exp_f32 v58, v58
    v_cvt_pk_bf16_f32 v56, v56, v57
    v_exp_f32 v59, v59
    v_exp_f32 v60, v60
    v_cvt_pk_bf16_f32 v57, v58, v59
    v_exp_f32 v61, v61
    s_waitcnt lgkmcnt(2)
    v_mfma_f32_32x32x16_bf16 v[40:55], v[12:15], v[8:11], 0
    ds_read_b128 v[12:15], v1 offset:62464
    v_exp_f32 v62, v62
    v_cvt_pk_bf16_f32 v58, v60, v61
    v_exp_f32 v63, v63
    v_exp_f32 v64, v64
    v_cvt_pk_bf16_f32 v59, v62, v63
    v_exp_f32 v65, v65
    v_exp_f32 v66, v66
    s_waitcnt lgkmcnt(1)
    v_mfma_f32_32x32x16_bf16 v[24:39], v[16:19], v[56:59], v[24:39]
    buffer_load_dwordx4 v[132:135], v1, s[36:39], s77 offen offset:3072 sc1
    s_cmp_eq_u32 s5, 7
    s_cbranch_scc1 L_nosa_79
    s_add_u32 s48, s79, 4096
    s_add_u32 m0, s88, 2048
    s_nop 0
    buffer_load_dwordx4 v1, s[36:39], s48 offen offset:0 sc1 lds
    buffer_load_dwordx4 v1, s[36:39], s48 offen offset:1024 sc1 lds
L_nosa_79:
    v_cvt_pk_bf16_f32 v64, v64, v65
    v_exp_f32 v67, v67
    v_exp_f32 v68, v68
    v_cvt_pk_bf16_f32 v65, v66, v67
    v_exp_f32 v69, v69
    v_exp_f32 v70, v70
    v_exp_f32 v71, v71
    v_cvt_pk_bf16_f32 v66, v68, v69
    v_cvt_pk_bf16_f32 v67, v70, v71
    v_exp_f32 v40, v40
    v_exp_f32 v41, v41
    v_mfma_f32_32x32x16_bf16 v[24:39], v[20:23], v[64:67], v[24:39]
    s_mov_b64 exec, s[10:11]
    ds_read_b128 v[16:19], v3 offset:61440
    ds_read_b128 v[20:23], v3 offset:61952
    s_mov_b64 exec, -1
    v_exp_f32 v42, v42
    v_cvt_pk_bf16_f32 v40, v40, v41
    v_exp_f32 v43, v43
    v_exp_f32 v44, v44
    v_cvt_pk_bf16_f32 v41, v42, v43
    v_exp_f32 v45, v45
    s_waitcnt lgkmcnt(2)
    v_mfma_f32_32x32x16_bf16 v[56:71], v[12:15], v[8:11], 0
    ds_read_b128 v[12:15], v1 offset:63488
    v_exp_f32 v46, v46
    v_cvt_pk_bf16_f32 v42, v44, v45
    v_exp_f32 v47, v47
    v_exp_f32 v48, v48
    v_cvt_pk_bf16_f32 v43, v46, v47
    v_exp_f32 v49, v49
    v_exp_f32 v50, v50
    s_waitcnt lgkmcnt(1)
    v_mfma_f32_32x32x16_bf16 v[24:39], v[16:19], v[40:43], v[24:39]
    v_cvt_pk_bf16_f32 v48, v48, v49
    v_exp_f32 v51, v51
    v_exp_f32 v52, v52
    v_cvt_pk_bf16_f32 v49, v50, v51
    v_exp_f32 v53, v53
    v_exp_f32 v54, v54
    v_exp_f32 v55, v55
    v_cvt_pk_bf16_f32 v50, v52, v53
    v_cvt_pk_bf16_f32 v51, v54, v55
    v_exp_f32 v56, v56
    v_exp_f32 v57, v57
    v_mfma_f32_32x32x16_bf16 v[24:39], v[20:23], v[48:51], v[24:39]
    s_mov_b64 exec, s[10:11]
    ds_read_b128 v[16:19], v3 offset:62464
    ds_read_b128 v[20:23], v3 offset:62976
    s_mov_b64 exec, -1
    v_exp_f32 v58, v58
    v_cvt_pk_bf16_f32 v56, v56, v57
    v_exp_f32 v59, v59
    v_exp_f32 v60, v60
    v_cvt_pk_bf16_f32 v57, v58, v59
    v_exp_f32 v61, v61
    s_waitcnt lgkmcnt(2)
    v_mfma_f32_32x32x16_bf16 v[40:55], v[12:15], v[8:11], 0
    ds_read_b128 v[12:15], v1 offset:64512
    v_exp_f32 v62, v62
    v_cvt_pk_bf16_f32 v58, v60, v61
    v_exp_f32 v63, v63
    v_exp_f32 v64, v64
    v_cvt_pk_bf16_f32 v59, v62, v63
    v_exp_f32 v65, v65
    v_exp_f32 v66, v66
    s_waitcnt lgkmcnt(1)
    v_mfma_f32_32x32x16_bf16 v[24:39], v[16:19], v[56:59], v[24:39]
    s_cmp_eq_u32 s5, 7
    s_cbranch_scc1 L_nosa_80
    s_add_u32 s48, s79, 6144
    s_add_u32 m0, s88, 4096
    s_nop 0
    buffer_load_dwordx4 v1, s[36:39], s48 offen offset:0 sc1 lds
    buffer_load_dwordx4 v1, s[36:39], s48 offen offset:1024 sc1 lds
L_nosa_80:
    v_cvt_pk_bf16_f32 v64, v64, v65
    v_exp_f32 v67, v67
    v_exp_f32 v68, v68
    v_cvt_pk_bf16_f32 v65, v66, v67
    v_exp_f32 v69, v69
    v_exp_f32 v70, v70
    v_exp_f32 v71, v71
    v_cvt_pk_bf16_f32 v66, v68, v69
    v_cvt_pk_bf16_f32 v67, v70, v71
    s_setprio 0
    v_exp_f32 v40, v40
    v_exp_f32 v41, v41
    v_mfma_f32_32x32x16_bf16 v[24:39], v[20:23], v[64:67], v[24:39]
    s_mov_b64 exec, s[10:11]
    ds_read_b128 v[16:19], v3 offset:63488
    ds_read_b128 v[20:23], v3 offset:64000
    s_mov_b64 exec, -1
    v_exp_f32 v42, v42
    v_cvt_pk_bf16_f32 v40, v40, v41
    v_exp_f32 v43, v43
    v_exp_f32 v44, v44
    v_cvt_pk_bf16_f32 v41, v42, v43
    v_exp_f32 v45, v45
    s_waitcnt lgkmcnt(2)
    v_mfma_f32_32x32x16_bf16 v[56:71], v[12:15], v[8:11], 0
    v_exp_f32 v46, v46
    v_cvt_pk_bf16_f32 v42, v44, v45
    v_exp_f32 v47, v47
    v_exp_f32 v48, v48
    v_cvt_pk_bf16_f32 v43, v46, v47
    v_exp_f32 v49, v49
    v_exp_f32 v50, v50
    s_waitcnt lgkmcnt(0)
    v_mfma_f32_32x32x16_bf16 v[24:39], v[16:19], v[40:43], v[24:39]
    v_cvt_pk_bf16_f32 v48, v48, v49
    v_exp_f32 v51, v51
    v_exp_f32 v52, v52
    v_cvt_pk_bf16_f32 v49, v50, v51
    v_exp_f32 v53, v53
    v_exp_f32 v54, v54
    v_exp_f32 v55, v55
    v_cvt_pk_bf16_f32 v50, v52, v53
    v_cvt_pk_bf16_f32 v51, v54, v55
    v_exp_f32 v56, v56
    v_exp_f32 v57, v57
    v_mfma_f32_32x32x16_bf16 v[24:39], v[20:23], v[48:51], v[24:39]
    s_mov_b64 exec, s[10:11]
    ds_read_b128 v[16:19], v3 offset:64512
    ds_read_b128 v[20:23], v3 offset:65024
    s_mov_b64 exec, -1
    v_exp_f32 v58, v58
    v_cvt_pk_bf16_f32 v56, v56, v57
    v_exp_f32 v59, v59
    v_exp_f32 v60, v60
    v_cvt_pk_bf16_f32 v57, v58, v59
    v_exp_f32 v61, v61
    v_exp_f32 v62, v62
    v_cvt_pk_bf16_f32 v58, v60, v61
    v_exp_f32 v63, v63
    v_exp_f32 v64, v64
    v_cvt_pk_bf16_f32 v59, v62, v63
    v_exp_f32 v65, v65
    v_exp_f32 v66, v66
    s_waitcnt lgkmcnt(0)
    v_mfma_f32_32x32x16_bf16 v[24:39], v[16:19], v[56:59], v[24:39]
    v_bfe_u32 v4, v0, 4, 1
    v_lshlrev_b32 v4, 10, v4
    v_sub_u32 v4, 67584, v4
    v_lshrrev_b32 v6, 5, v0
    v_lshl_add_u32 v4, v6, 4, v4
    s_and_b32 s48, s87, 0
    s_lshl_b32 s48, s48, 8
    v_add_u32 v4, s48, v4
    v_cvt_pk_bf16_f32 v64, v64, v65
    v_exp_f32 v67, v67
    v_exp_f32 v68, v68
    v_cvt_pk_bf16_f32 v65, v66, v67
    v_exp_f32 v69, v69
    v_exp_f32 v70, v70
    v_exp_f32 v71, v71
    v_cvt_pk_bf16_f32 v66, v68, v69
    v_cvt_pk_bf16_f32 v67, v70, v71
    s_nop 1
    v_mfma_f32_32x32x16_bf16 v[24:39], v[20:23], v[64:67], v[24:39]
    s_setprio 3
    v_mov_b32 v46, 1568669696
    v_mov_b32 v47, 2113929216
    v_lshrrev_b32 v3, 4, v0
    v_lshlrev_b32 v2, 3, v3
    s_add_u32 s48, s80, 65536
    v_add_u32 v6, s48, v2
    s_nop 4
    v_rcp_f32 v52, v32
    v_max3_f32 v40, abs(v24), abs(v25), abs(v26)
    v_max3_f32 v41, abs(v27), abs(v28), abs(v29)
    v_add_f32 v42, v24, v25
    v_add_f32 v43, v26, v27
    v_max3_f32 v40, v40, abs(v30), abs(v31)
    v_add_f32 v44, v28, v29
    v_add_f32 v45, v30, v31
    v_max_f32 v40, v40, v41
    v_add_f32 v42, v42, v43
    v_add_f32 v44, v44, v45
    v_cmp_nlt_f32 vcc, 562036736, v32
    v_cmp_nlt_f32 s[50:51], v32, v46
    v_cmp_nlt_f32 s[52:53], v40, v47
    v_cmp_u_f32 s[54:55], v42, v44
    s_or_b64 vcc, vcc, s[50:51]
    s_or_b64 s[52:53], s[52:53], s[54:55]
    s_or_b64 vcc, vcc, s[52:53]
    s_cbranch_scc1 L_slow
L_norm2:
    v_mul_f32 v24, v24, v52
    v_mul_f32 v25, v25, v52
    v_mul_f32 v26, v26, v52
    v_mul_f32 v27, v27, v52
    v_mul_f32 v28, v28, v52
    v_mul_f32 v29, v29, v52
    v_mul_f32 v30, v30, v52
    v_mul_f32 v31, v31, v52
    v_cvt_pk_bf16_f32 v44, v24, v25
    v_cvt_pk_bf16_f32 v45, v26, v27
    v_cvt_pk_bf16_f32 v46, v28, v29
    v_cvt_pk_bf16_f32 v47, v30, v31
    v_min_u32 v44, -2, v44
    buffer_store_dwordx4 v[44:47], v1, s[36:39], s16 offen sc1
    buffer_load_dwordx4 v[64:67], v1, s[36:39], s76 offen offset:2048 sc1
    buffer_load_dwordx4 v[68:71], v1, s[36:39], s76 offen offset:3072 sc1
    ds_read_b128 v[8:11], v4
    ds_read_b128 v[12:15], v4 offset:32
    ds_read_b128 v[16:19], v4 offset:64
    ds_read_b64 v[60:61], v6
    ds_read_b64 v[62:63], v6 offset:2048
    s_setprio 0
    s_waitcnt vmcnt(3)
    s_waitcnt lgkmcnt(4)
    v_mfma_f32_32x32x16_bf16 v[24:39], v[136:139], v[8:11], 0
    ds_read_b128 v[20:23], v4 offset:96
    s_waitcnt lgkmcnt(4)
    v_mfma_f32_32x32x16_bf16 v[24:39], v[140:143], v[12:15], v[24:39]
    ds_read_b128 v[8:11], v4 offset:128
    s_waitcnt lgkmcnt(4)
    v_mfma_f32_32x32x16_bf16 v[24:39], v[144:147], v[16:19], v[24:39]
    ds_read_b128 v[12:15], v4 offset:160
    s_waitcnt lgkmcnt(2)
    v_mfma_f32_32x32x16_bf16 v[24:39], v[148:151], v[20:23], v[24:39]
    ds_read_b128 v[16:19], v4 offset:192
    s_waitcnt lgkmcnt(2)
    v_mfma_f32_32x32x16_bf16 v[24:39], v[152:155], v[8:11], v[24:39]
    ds_read_b128 v[20:23], v4 offset:224
    s_waitcnt lgkmcnt(2)
    v_mfma_f32_32x32x16_bf16 v[24:39], v[156:159], v[12:15], v[24:39]
    v_xor_b32 v4, 256, v4
    ds_read_b128 v[8:11], v4
    s_waitcnt lgkmcnt(2)
    v_mfma_f32_32x32x16_bf16 v[24:39], v[160:163], v[16:19], v[24:39]
    ds_read_b128 v[12:15], v4 offset:32
    s_waitcnt lgkmcnt(2)
    v_mfma_f32_32x32x16_bf16 v[24:39], v[164:167], v[20:23], v[24:39]
    ds_read_b128 v[16:19], v4 offset:64
    s_waitcnt lgkmcnt(2)
    v_mfma_f32_32x32x16_bf16 v[24:39], v[168:171], v[8:11], v[24:39]
    ds_read_b128 v[20:23], v4 offset:96
    s_waitcnt lgkmcnt(2)
    v_mfma_f32_32x32x16_bf16 v[24:39], v[172:175], v[12:15], v[24:39]
    ds_read_b128 v[8:11], v4 offset:128
    s_waitcnt lgkmcnt(2)
    v_mfma_f32_32x32x16_bf16 v[24:39], v[176:179], v[16:19], v[24:39]
    ds_read_b128 v[12:15], v4 offset:160
    s_waitcnt lgkmcnt(2)
    v_mfma_f32_32x32x16_bf16 v[24:39], v[180:183], v[20:23], v[24:39]
    ds_read_b128 v[16:19], v4 offset:192
    s_waitcnt lgkmcnt(2)
    v_mfma_f32_32x32x16_bf16 v[24:39], v[184:187], v[8:11], v[24:39]
    ds_read_b128 v[20:23], v4 offset:224
    s_waitcnt lgkmcnt(2)
    v_mfma_f32_32x32x16_bf16 v[24:39], v[188:191], v[12:15], v[24:39]
    v_xor_b32 v4, 768, v4
    ds_read_b128 v[8:11], v4
    s_waitcnt lgkmcnt(2)
    v_mfma_f32_32x32x16_bf16 v[24:39], v[192:195], v[16:19], v[24:39]
    ds_read_b128 v[12:15], v4 offset:32
    s_waitcnt lgkmcnt(2)
    v_mfma_f32_32x32x16_bf16 v[24:39], v[196:199], v[20:23], v[24:39]
    ds_read_b128 v[16:19], v4 offset:64
    s_waitcnt vmcnt(2)
    s_barrier
    s_mov_b32 m0, s89
    s_nop 0
    buffer_load_dwordx4 v1, s[36:39], s91 offen offset:0 sc1 lds
    s_mov_b32 m0, s89
    s_nop 0
    buffer_load_dwordx4 v1, s[36:39], s91 offen offset:1024 sc1 lds
    s_mov_b32 m0, s89
    s_nop 0
    buffer_load_dwordx4 v1, s[36:39], s91 offen offset:2048 sc1 lds
    s_mov_b32 m0, s89
    s_nop 0
    buffer_load_dwordx4 v1, s[36:39], s91 offen offset:3072 sc1 lds
    s_waitcnt lgkmcnt(2)
    v_mfma_f32_32x32x16_bf16 v[24:39], v[200:203], v[8:11], v[24:39]
    ds_read_b128 v[20:23], v4 offset:96
    s_waitcnt lgkmcnt(2)
    v_mfma_f32_32x32x16_bf16 v[24:39], v[204:207], v[12:15], v[24:39]
    ds_read_b128 v[8:11], v4 offset:128
    s_waitcnt lgkmcnt(2)
    v_mfma_f32_32x32x16_bf16 v[24:39], v[208:211], v[16:19], v[24:39]
    ds_read_b128 v[12:15], v4 offset:160
    s_waitcnt lgkmcnt(2)
    v_mfma_f32_32x32x16_bf16 v[24:39], v[212:215], v[20:23], v[24:39]
    ds_read_b128 v[16:19], v4 offset:192
    s_waitcnt lgkmcnt(2)
    v_mfma_f32_32x32x16_bf16 v[24:39], v[216:219], v[8:11], v[24:39]
    ds_read_b128 v[20:23], v4 offset:224
    s_waitcnt lgkmcnt(2)
    v_mfma_f32_32x32x16_bf16 v[24:39], v[220:223], v[12:15], v[24:39]
    v_xor_b32 v4, 256, v4
    ds_read_b128 v[8:11], v4
    s_waitcnt lgkmcnt(2)
    v_mfma_f32_32x32x16_bf16 v[24:39], v[224:227], v[16:19], v[24:39]
    ds_read_b128 v[12:15], v4 offset:32
    s_waitcnt lgkmcnt(2)
    v_mfma_f32_32x32x16_bf16 v[24:39], v[228:231], v[20:23], v[24:39]
    ds_read_b128 v[16:19], v4 offset:64
    s_waitcnt lgkmcnt(2)
    v_mfma_f32_32x32x16_bf16 v[24:39], v[232:235], v[8:11], v[24:39]
    ds_read_b128 v[20:23], v4 offset:96
    s_waitcnt lgkmcnt(2)
    v_mfma_f32_32x32x16_bf16 v[24:39], v[236:239], v[12:15], v[24:39]
    s_waitcnt lgkmcnt(1)
    v_mfma_f32_32x32x16_bf16 v[24:39], v[240:243], v[16:19], v[24:39]
    s_waitcnt lgkmcnt(0)
    v_mfma_f32_32x32x16_bf16 v[24:39], v[244:247], v[20:23], v[24:39]
    v_and_b32 v5, 15, v0
    v_lshl_add_u32 v2, v5, 8, v2
    s_lshl_b32 s48, s5, 5
    s_add_u32 s48, s48, 155648
    v_add_u32 v2, s48, v2
    v_lshlrev_b32 v3, 9, v3
    v_lshl_add_u32 v3, v5, 4, v3
    v_add_u32 v5, s89, v1
    v_lshlrev_b32 v6, 2, v0
    s_waitcnt vmcnt(0)
L_ck_81:
    ds_read_b32 v40, v5 offset:0
    ds_read_b32 v41, v5 offset:1024
    ds_read_b32 v42, v5 offset:2048
    ds_read_b32 v43, v5 offset:3072
    s_waitcnt lgkmcnt(0)
    v_max_u32 v44, v40, v41
    v_max3_u32 v44, v44, v42, v43
    v_cmp_eq_u32 vcc, -1, v44
    s_cbranch_vccnz L_cr_82
L_cd_83:
    s_barrier
    s_setprio 3
    ds_read_b128 v[16:19], v3
    ds_read_b128 v[20:23], v3 offset:256
    ds_read_b128 v[40:43], v3 offset:2048
    ds_read_b128 v[44:47], v3 offset:2304
    ds_read_b128 v[52:55], v3 offset:4096
    s_add_u32 s48, s79, 8192
    s_add_u32 m0, s17, 0
    s_nop 0
    buffer_load_dwordx4 v1, s[36:39], s48 offen offset:0 sc1 lds
    buffer_load_dwordx4 v1, s[36:39], s48 offen offset:1024 sc1 lds
    buffer_load_dwordx4 v1, s[36:39], s48 offen offset:2048 sc1 lds
    buffer_load_dwordx4 v1, s[36:39], s48 offen offset:3072 sc1 lds
    s_waitcnt lgkmcnt(4)
    v_mfma_f32_16x16x32_bf16 v[8:11], v[72:75], v[16:19], 0
    ds_read_b128 v[56:59], v3 offset:4352
    s_waitcnt lgkmcnt(4)
    v_mfma_f32_16x16x32_bf16 v[12:15], v[72:75], v[20:23], 0
    ds_read_b128 v[16:19], v3 offset:6144
    s_waitcnt lgkmcnt(4)
    v_mfma_f32_16x16x32_bf16 v[8:11], v[76:79], v[40:43], v[8:11]
    ds_read_b128 v[20:23], v3 offset:6400
    s_waitcnt lgkmcnt(4)
    v_mfma_f32_16x16x32_bf16 v[12:15], v[76:79], v[44:47], v[12:15]
    ds_read_b128 v[40:43], v3 offset:8192
    s_waitcnt lgkmcnt(4)
    v_mfma_f32_16x16x32_bf16 v[8:11], v[80:83], v[52:55], v[8:11]
    ds_read_b128 v[44:47], v3 offset:8448
    s_waitcnt lgkmcnt(4)
    v_mfma_f32_16x16x32_bf16 v[12:15], v[80:83], v[56:59], v[12:15]
    ds_read_b128 v[52:55], v3 offset:10240
    s_waitcnt lgkmcnt(4)
    v_mfma_f32_16x16x32_bf16 v[8:11], v[84:87], v[16:19], v[8:11]
    ds_read_b128 v[56:59], v3 offset:10496
    s_waitcnt lgkmcnt(4)
    v_mfma_f32_16x16x32_bf16 v[12:15], v[84:87], v[20:23], v[12:15]
    ds_read_b128 v[16:19], v3 offset:12288
    s_waitcnt lgkmcnt(4)
    v_mfma_f32_16x16x32_bf16 v[8:11], v[88:91], v[40:43], v[8:11]
    ds_read_b128 v[20:23], v3 offset:12544
    s_waitcnt lgkmcnt(4)
    v_mfma_f32_16x16x32_bf16 v[12:15], v[88:91], v[44:47], v[12:15]
    ds_read_b128 v[40:43], v3 offset:14336
    s_waitcnt lgkmcnt(4)
    v_mfma_f32_16x16x32_bf16 v[8:11], v[92:95], v[52:55], v[8:11]
    ds_read_b128 v[44:47], v3 offset:14592
    ds_read_b64 v[88:89], v2
    s_waitcnt lgkmcnt(5)
    v_mfma_f32_16x16x32_bf16 v[12:15], v[92:95], v[56:59], v[12:15]
    ds_read_b128 v[52:55], v3 offset:16384
    ds_read_b64 v[90:91], v2 offset:4096
    s_waitcnt lgkmcnt(6)
    v_mfma_f32_16x16x32_bf16 v[8:11], v[96:99], v[16:19], v[8:11]
    ds_read_b128 v[56:59], v3 offset:16640
    v_and_b32 v73, 4294901760, v60
    s_waitcnt lgkmcnt(6)
    v_mfma_f32_16x16x32_bf16 v[12:15], v[96:99], v[20:23], v[12:15]
    ds_read_b128 v[16:19], v3 offset:18432
    v_lshlrev_b32 v72, 16, v60
    s_waitcnt lgkmcnt(6)
    v_mfma_f32_16x16x32_bf16 v[8:11], v[100:103], v[40:43], v[8:11]
    ds_read_b128 v[20:23], v3 offset:18688
    v_and_b32 v75, 4294901760, v61
    s_waitcnt lgkmcnt(6)
    v_mfma_f32_16x16x32_bf16 v[12:15], v[100:103], v[44:47], v[12:15]
    ds_read_b128 v[40:43], v3 offset:20480
    v_lshlrev_b32 v74, 16, v61
    s_waitcnt lgkmcnt(5)
    v_mfma_f32_16x16x32_bf16 v[8:11], v[104:107], v[52:55], v[8:11]
    ds_read_b128 v[44:47], v3 offset:20736
    v_and_b32 v77, 4294901760, v62
    s_waitcnt lgkmcnt(4)
    v_mfma_f32_16x16x32_bf16 v[12:15], v[104:107], v[56:59], v[12:15]
    ds_read_b128 v[52:55], v3 offset:22528
    v_lshlrev_b32 v76, 16, v62
    s_waitcnt lgkmcnt(4)
    v_mfma_f32_16x16x32_bf16 v[8:11], v[108:111], v[16:19], v[8:11]
    ds_read_b128 v[56:59], v3 offset:22784
    v_and_b32 v79, 4294901760, v63
    s_waitcnt lgkmcnt(4)
    v_mfma_f32_16x16x32_bf16 v[12:15], v[108:111], v[20:23], v[12:15]
    ds_read_b128 v[16:19], v3 offset:24576
    v_lshlrev_b32 v78, 16, v63
    s_waitcnt lgkmcnt(4)
    v_mfma_f32_16x16x32_bf16 v[8:11], v[112:115], v[40:43], v[8:11]
    ds_read_b128 v[20:23], v3 offset:24832
    v_and_b32 v81, 4294901760, v88
    s_waitcnt lgkmcnt(4)
    v_mfma_f32_16x16x32_bf16 v[12:15], v[112:115], v[44:47], v[12:15]
    ds_read_b128 v[40:43], v3 offset:26624
    v_lshlrev_b32 v80, 16, v88
    s_waitcnt lgkmcnt(4)
    v_mfma_f32_16x16x32_bf16 v[8:11], v[116:119], v[52:55], v[8:11]
    ds_read_b128 v[44:47], v3 offset:26880
    v_and_b32 v83, 4294901760, v89
    s_waitcnt lgkmcnt(4)
    v_mfma_f32_16x16x32_bf16 v[12:15], v[116:119], v[56:59], v[12:15]
    ds_read_b128 v[52:55], v3 offset:28672
    v_lshlrev_b32 v82, 16, v89
    s_waitcnt lgkmcnt(4)
    v_mfma_f32_16x16x32_bf16 v[8:11], v[120:123], v[16:19], v[8:11]
    ds_read_b128 v[56:59], v3 offset:28928
    v_and_b32 v85, 4294901760, v90
    s_waitcnt lgkmcnt(4)
    v_mfma_f32_16x16x32_bf16 v[12:15], v[120:123], v[20:23], v[12:15]
    ds_read_b128 v[16:19], v3 offset:30720
    v_lshlrev_b32 v84, 16, v90
    s_waitcnt lgkmcnt(4)
    v_mfma_f32_16x16x32_bf16 v[8:11], v[124:127], v[40:43], v[8:11]
    ds_read_b128 v[20:23], v3 offset:30976
    v_and_b32 v87, 4294901760, v91
    s_waitcnt lgkmcnt(4)
    v_mfma_f32_16x16x32_bf16 v[12:15], v[124:127], v[44:47], v[12:15]
    v_lshlrev_b32 v86, 16, v91
    s_waitcnt lgkmcnt(3)
    v_mfma_f32_16x16x32_bf16 v[8:11], v[128:131], v[52:55], v[8:11]
    s_waitcnt lgkmcnt(2)
    v_mfma_f32_16x16x32_bf16 v[12:15], v[128:131], v[56:59], v[12:15]
    s_waitcnt lgkmcnt(1)
    v_mfma_f32_16x16x32_bf16 v[8:11], v[132:135], v[16:19], v[8:11]
    s_waitcnt lgkmcnt(0)
    v_mfma_f32_16x16x32_bf16 v[12:15], v[132:135], v[20:23], v[12:15]
    s_nop 5
    v_fma_f32 v8, v8, v72, v80
    v_fma_f32 v9, v9, v73, v81
    v_fma_f32 v10, v10, v74, v82
    v_fma_f32 v11, v11, v75, v83
    v_fma_f32 v12, v12, v72, v84
    v_fma_f32 v13, v13, v73, v85
    v_fma_f32 v14, v14, v74, v86
    v_fma_f32 v15, v15, v75, v87
    v_mul_f32 v16, v8, v76
    v_mul_f32 v17, v9, v77
    v_mul_f32 v18, v10, v78
    v_mul_f32 v19, v11, v79
    v_mul_f32 v20, v12, v76
    v_mul_f32 v21, v13, v77
    v_mul_f32 v22, v14, v78
    v_mul_f32 v23, v15, v79
    v_cvt_pk_bf16_f32 v40, v16, v17
    v_cvt_pk_bf16_f32 v41, v18, v19
    v_cvt_pk_bf16_f32 v42, v20, v21
    v_cvt_pk_bf16_f32 v43, v22, v23
    v_add_f32 v52, v8, v9
    v_mul_f32 v54, v8, v8
    v_add_f32 v53, v12, v13
    v_mul_f32 v55, v12, v12
    v_permlane16_swap_b32 v40, v42
    v_permlane16_swap_b32 v41, v43
    v_min_u32 v40, -2, v40
    buffer_store_dwordx4 v[40:43], v1, s[36:39], s69 offen sc1
    v_add_f32 v56, v10, v11
    v_fmac_f32 v54, v9, v9
    v_add_f32 v57, v14, v15
    v_fmac_f32 v55, v13, v13
    v_add_f32 v52, v52, v56
    v_fmac_f32 v54, v10, v10
    v_add_f32 v53, v53, v57
    v_fmac_f32 v55, v14, v14
    v_fmac_f32 v54, v11, v11
    v_fmac_f32 v55, v15, v15
    v_cvt_pk_bf16_f32 v44, v8, v9
    v_cvt_pk_bf16_f32 v45, v10, v11
    v_cvt_pk_bf16_f32 v46, v12, v13
    v_cvt_pk_bf16_f32 v47, v14, v15
    v_permlane16_swap_b32 v52, v53
    v_permlane16_swap_b32 v54, v55
    v_add_f32 v52, v52, v53
    v_add_f32 v54, v54, v55
    v_permlane16_swap_b32 v44, v46
    v_permlane16_swap_b32 v45, v47
    v_permlane32_swap_b32 v52, v54
    v_min_u32 v44, -2, v44
    v_min_u32 v46, -2, v46
    v_add_f32 v52, v52, v54
    v_min_u32 v52, -2, v52
    buffer_store_dword v52, v6, s[36:39], s71 offen sc1
    buffer_store_dwordx4 v[44:47], v1, s[36:39], s70 offen sc1
    ds_read_b128 v[8:11], v4 offset:128
    ds_read_b128 v[12:15], v4 offset:160
    ds_read_b128 v[16:19], v4 offset:192
    s_setprio 0
    s_waitcnt lgkmcnt(2)
    v_mfma_f32_32x32x16_bf16 v[24:39], v[248:251], v[8:11], v[24:39]
    ds_read_b128 v[20:23], v4 offset:224
    s_waitcnt lgkmcnt(2)
    v_mfma_f32_32x32x16_bf16 v[24:39], v[252:255], v[12:15], v[24:39]
    s_waitcnt lgkmcnt(1)
    v_mfma_f32_32x32x16_bf16 v[24:39], v[64:67], v[16:19], v[24:39]
    s_waitcnt lgkmcnt(0)
    v_mfma_f32_32x32x16_bf16 v[24:39], v[68:71], v[20:23], v[24:39]
    v_add_u32 v3, s88, v1
    v_add_u32 v4, s17, v1
    v_add_u32 v5, 106496, v1
    v_and_b32 v60, 31, v0
    v_lshlrev_b32 v60, 3, v60
    v_add_u32 v60, 69632, v60
    s_lshl_b32 s48, s5, 8
    s_add_u32 s48, s48, 71680
    v_add_u32 v49, s48, v6
    v_and_b32 v2, 128, v6
    v_add_u32 v2, s48, v2
    v_add_u32 v6, s27, v1
    s_mov_b32 s50, 65537
    s_mov_b32 s51, 65537
    s_mov_b64 exec, s[50:51]
    ds_write_b128 v49, v[24:27]
    ds_write_b128 v49, v[28:31] offset:16
    ds_write_b128 v49, v[32:35] offset:32
    ds_write_b128 v49, v[36:39] offset:48
    s_mov_b64 exec, -1
    s_waitcnt vmcnt(0)
    s_barrier
    s_mov_b32 m0, s27
    s_nop 0
    buffer_load_dwordx4 v1, s[36:39], s25 offen offset:0 sc1 lds
    s_mov_b32 m0, s27
    s_nop 0
    buffer_load_dwordx4 v1, s[36:39], s25 offen offset:1024 sc1 lds
    s_mov_b32 m0, s27
    s_nop 0
    buffer_load_dwordx4 v1, s[36:39], s25 offen offset:2048 sc1 lds
    s_mov_b32 m0, s27
    s_nop 0
    buffer_load_dwordx4 v1, s[36:39], s25 offen offset:3072 sc1 lds
    s_cmp_eq_u32 s5, 7
    s_cbranch_scc1 L_w7
    s_waitcnt vmcnt(0)
L_ck_88:
    ds_read_b32 v8, v6 offset:0
    ds_read_b32 v9, v6 offset:1024
    ds_read_b32 v10, v6 offset:2048
    ds_read_b32 v11, v6 offset:3072
    s_waitcnt lgkmcnt(0)
    v_max_u32 v12, v8, v9
    v_max3_u32 v12, v12, v10, v11
    v_cmp_eq_u32 vcc, -1, v12
    s_cbranch_vccnz L_cr_89
L_cd_90:
    s_barrier
    ds_read_b128 v[40:43], v1
    ds_read_b128 v[44:47], v1 offset:1024
    ds_read_b128 v[48:51], v1 offset:2048
    ds_read_b128 v[52:55], v1 offset:3072
    s_setprio 3
    s_waitcnt lgkmcnt(3)
    v_mfma_f32_32x32x16_bf16 v[8:23], v[136:139], v[40:43], 0
    ds_read_b128 v[56:59], v1 offset:4096
    s_waitcnt lgkmcnt(3)
    v_mfma_f32_32x32x16_bf16 v[8:23], v[140:143], v[44:47], v[8:23]
    ds_read_b128 v[40:43], v1 offset:5120
    s_waitcnt lgkmcnt(3)
    v_mfma_f32_32x32x16_bf16 v[8:23], v[144:147], v[48:51], v[8:23]
    ds_read_b128 v[44:47], v1 offset:6144
    s_waitcnt lgkmcnt(3)
    v_mfma_f32_32x32x16_bf16 v[8:23], v[148:151], v[52:55], v[8:23]
    ds_read_b128 v[48:51], v1 offset:7168
    s_waitcnt lgkmcnt(3)
    v_mfma_f32_32x32x16_bf16 v[8:23], v[152:155], v[56:59], v[8:23]
    ds_read_b128 v[52:55], v1 offset:8192
    s_waitcnt lgkmcnt(3)
    v_mfma_f32_32x32x16_bf16 v[8:23], v[156:159], v[40:43], v[8:23]
    ds_read_b128 v[56:59], v1 offset:9216
    s_waitcnt lgkmcnt(3)
    v_mfma_f32_32x32x16_bf16 v[8:23], v[160:163], v[44:47], v[8:23]
    ds_read_b128 v[40:43], v1 offset:10240
    s_waitcnt lgkmcnt(3)
    v_mfma_f32_32x32x16_bf16 v[8:23], v[164:167], v[48:51], v[8:23]
    ds_read_b128 v[44:47], v1 offset:11264
    s_waitcnt lgkmcnt(3)
    v_mfma_f32_32x32x16_bf16 v[8:23], v[168:171], v[52:55], v[8:23]
    ds_read_b128 v[48:51], v1 offset:12288
    s_waitcnt lgkmcnt(3)
    v_mfma_f32_32x32x16_bf16 v[8:23], v[172:175], v[56:59], v[8:23]
    ds_read_b128 v[52:55], v1 offset:13312
    s_waitcnt lgkmcnt(3)
    v_mfma_f32_32x32x16_bf16 v[8:23], v[176:179], v[40:43], v[8:23]
    ds_read_b128 v[56:59], v1 offset:14336
    s_waitcnt lgkmcnt(3)
    v_mfma_f32_32x32x16_bf16 v[8:23], v[180:183], v[44:47], v[8:23]
    ds_read_b128 v[40:43], v1 offset:15360
    s_waitcnt lgkmcnt(3)
    v_mfma_f32_32x32x16_bf16 v[8:23], v[184:187], v[48:51], v[8:23]
    ds_read_b128 v[44:47], v1 offset:16384
    s_waitcnt lgkmcnt(3)
    v_mfma_f32_32x32x16_bf16 v[8:23], v[188:191], v[52:55], v[8:23]
    ds_read_b128 v[48:51], v1 offset:17408
    s_waitcnt lgkmcnt(3)
    v_mfma_f32_32x32x16_bf16 v[8:23], v[192:195], v[56:59], v[8:23]
    ds_read_b128 v[52:55], v1 offset:18432
    s_waitcnt lgkmcnt(3)
    v_mfma_f32_32x32x16_bf16 v[8:23], v[196:199], v[40:43], v[8:23]
    ds_read_b128 v[56:59], v1 offset:19456
    s_setprio 2
    s_waitcnt lgkmcnt(3)
    v_mfma_f32_32x32x16_bf16 v[8:23], v[200:203], v[44:47], v[8:23]
    ds_read_b128 v[40:43], v1 offset:20480
    s_waitcnt lgkmcnt(3)
    v_mfma_f32_32x32x16_bf16 v[8:23], v[204:207], v[48:51], v[8:23]
    ds_read_b128 v[44:47], v1 offset:21504
    s_waitcnt lgkmcnt(3)
    v_mfma_f32_32x32x16_bf16 v[8:23], v[208:211], v[52:55], v[8:23]
    ds_read_b128 v[48:51], v1 offset:22528
    s_add_u32 s78, s79, 12288
    buffer_load_dwordx4 v[72:75], v1, s[36:39], s78 offen offset:0 sc1
    s_waitcnt lgkmcnt(3)
    v_mfma_f32_32x32x16_bf16 v[8:23], v[212:215], v[56:59], v[8:23]
    ds_read_b128 v[52:55], v1 offset:23552
    buffer_load_dwordx4 v[76:79], v1, s[36:39], s78 offen offset:1024 sc1
    s_waitcnt lgkmcnt(3)
    v_mfma_f32_32x32x16_bf16 v[8:23], v[216:219], v[40:43], v[8:23]
    ds_read_b128 v[56:59], v1 offset:24576
    buffer_load_dwordx4 v[80:83], v1, s[36:39], s78 offen offset:2048 sc1
    s_waitcnt lgkmcnt(3)
    v_mfma_f32_32x32x16_bf16 v[8:23], v[220:223], v[44:47], v[8:23]
    ds_read_b128 v[40:43], v1 offset:25600
    buffer_load_dwordx4 v[84:87], v1, s[36:39], s78 offen offset:3072 sc1
    s_waitcnt lgkmcnt(3)
    v_mfma_f32_32x32x16_bf16 v[8:23], v[224:227], v[48:51], v[8:23]
    ds_read_b128 v[44:47], v1 offset:26624
    s_add_u32 s78, s79, 16384
    buffer_load_dwordx4 v[88:91], v1, s[36:39], s78 offen offset:0 sc1
    s_waitcnt lgkmcnt(3)
    v_mfma_f32_32x32x16_bf16 v[8:23], v[228:231], v[52:55], v[8:23]
    ds_read_b128 v[48:51], v1 offset:27648
    buffer_load_dwordx4 v[92:95], v1, s[36:39], s78 offen offset:1024 sc1
    s_waitcnt lgkmcnt(3)
    v_mfma_f32_32x32x16_bf16 v[8:23], v[232:235], v[56:59], v[8:23]
    ds_read_b128 v[52:55], v1 offset:28672
    buffer_load_dwordx4 v[96:99], v1, s[36:39], s78 offen offset:2048 sc1
    s_waitcnt lgkmcnt(3)
    v_mfma_f32_32x32x16_bf16 v[8:23], v[236:239], v[40:43], v[8:23]
    ds_read_b128 v[56:59], v1 offset:29696
    buffer_load_dwordx4 v[100:103], v1, s[36:39], s78 offen offset:3072 sc1
    s_waitcnt lgkmcnt(3)
    v_mfma_f32_32x32x16_bf16 v[8:23], v[240:243], v[44:47], v[8:23]
    ds_read_b128 v[40:43], v1 offset:30720
    s_add_u32 s78, s79, 20480
    buffer_load_dwordx4 v[104:107], v1, s[36:39], s78 offen offset:0 sc1
    s_waitcnt lgkmcnt(3)
    v_mfma_f32_32x32x16_bf16 v[8:23], v[244:247], v[48:51], v[8:23]
    ds_read_b128 v[44:47], v1 offset:31744
    buffer_load_dwordx4 v[108:111], v1, s[36:39], s78 offen offset:1024 sc1
    s_barrier
    ds_read_b64 v[62:63], v60 offset:256
    ds_read_b64 v[60:61], v60
    s_waitcnt lgkmcnt(5)
    v_mfma_f32_32x32x16_bf16 v[8:23], v[248:251], v[52:55], v[8:23]
    ds_read_b128 v[48:51], v5
    buffer_load_dwordx4 v[112:115], v1, s[36:39], s78 offen offset:2048 sc1
    s_waitcnt lgkmcnt(5)
    v_mfma_f32_32x32x16_bf16 v[8:23], v[252:255], v[56:59], v[8:23]
    ds_read_b128 v[52:55], v5 offset:1024
    buffer_load_dwordx4 v[116:119], v1, s[36:39], s78 offen offset:3072 sc1
    s_waitcnt lgkmcnt(5)
    v_mfma_f32_32x32x16_bf16 v[8:23], v[64:67], v[40:43], v[8:23]
    ds_read_b128 v[56:59], v5 offset:2048
    s_add_u32 s78, s79, 24576
    buffer_load_dwordx4 v[120:123], v1, s[36:39], s78 offen offset:0 sc1
    s_waitcnt lgkmcnt(5)
    v_mfma_f32_32x32x16_bf16 v[8:23], v[68:71], v[44:47], v[8:23]
    ds_read_b128 v[40:43], v5 offset:3072
    buffer_load_dwordx4 v[124:127], v1, s[36:39], s78 offen offset:1024 sc1
    s_waitcnt lgkmcnt(3)
    v_mfma_f32_32x32x16_bf16 v[24:39], v[136:139], v[48:51], 0
    ds_read_b128 v[44:47], v5 offset:4096
    buffer_load_dwordx4 v[128:131], v1, s[36:39], s78 offen offset:2048 sc1
    s_waitcnt lgkmcnt(3)
    v_mfma_f32_32x32x16_bf16 v[24:39], v[140:143], v[52:55], v[24:39]
    ds_read_b128 v[48:51], v5 offset:5120
    ds_read_b128 v[136:139], v2
    buffer_load_dwordx4 v[132:135], v1, s[36:39], s78 offen offset:3072 sc1
    s_waitcnt lgkmcnt(4)
    v_mfma_f32_32x32x16_bf16 v[24:39], v[144:147], v[56:59], v[24:39]
    ds_read_b128 v[52:55], v5 offset:6144
    ds_read_b128 v[140:143], v2 offset:16
    s_waitcnt lgkmcnt(5)
    v_mfma_f32_32x32x16_bf16 v[24:39], v[148:151], v[40:43], v[24:39]
    ds_read_b128 v[56:59], v5 offset:7168
    ds_read_b128 v[144:147], v2 offset:64
    s_waitcnt lgkmcnt(6)
    v_mfma_f32_32x32x16_bf16 v[24:39], v[152:155], v[44:47], v[24:39]
    ds_read_b128 v[40:43], v5 offset:8192
    ds_read_b128 v[148:151], v2 offset:80
    s_waitcnt lgkmcnt(7)
    v_mfma_f32_32x32x16_bf16 v[24:39], v[156:159], v[48:51], v[24:39]
    ds_read_b128 v[44:47], v5 offset:9216
    ds_read_b128 v[152:155], v2 offset:32
    s_waitcnt lgkmcnt(7)
    v_mfma_f32_32x32x16_bf16 v[24:39], v[160:163], v[52:55], v[24:39]
    ds_read_b128 v[48:51], v5 offset:10240
    ds_read_b128 v[156:159], v2 offset:48
    s_waitcnt lgkmcnt(4)
    v_fma_f32 v8, -v60, v136, v8
    v_fma_f32 v9, -v60, v137, v9
    v_fma_f32 v10, -v60, v138, v10
    v_fma_f32 v11, -v60, v139, v11
    v_fma_f32 v12, -v60, v140, v12
    v_fma_f32 v13, -v60, v141, v13
    v_mfma_f32_32x32x16_bf16 v[24:39], v[164:167], v[56:59], v[24:39]
    ds_read_b128 v[52:55], v5 offset:11264
    ds_read_b128 v[160:163], v2 offset:96
    v_fma_f32 v14, -v60, v142, v14
    v_fma_f32 v15, -v60, v143, v15
    v_fma_f32 v8, v8, v61, v144
    v_fma_f32 v9, v9, v61, v145
    v_fma_f32 v10, v10, v61, v146
    v_fma_f32 v11, v11, v61, v147
    v_fma_f32 v12, v12, v61, v148
    v_mfma_f32_32x32x16_bf16 v[24:39], v[168:171], v[40:43], v[24:39]
    ds_read_b128 v[56:59], v5 offset:12288
    ds_read_b128 v[164:167], v2 offset:112
    v_fma_f32 v13, v13, v61, v149
    v_fma_f32 v14, v14, v61, v150
    v_fma_f32 v15, v15, v61, v151
    v_max_f32 v8, 0, v8
    v_max_f32 v9, 0, v9
    v_max_f32 v10, 0, v10
    v_max_f32 v11, 0, v11
    s_waitcnt lgkmcnt(7)
    v_mfma_f32_32x32x16_bf16 v[24:39], v[172:175], v[44:47], v[24:39]
    ds_read_b128 v[40:43], v5 offset:13312
    v_max_f32 v12, 0, v12
    v_max_f32 v13, 0, v13
    v_max_f32 v14, 0, v14
    v_max_f32 v15, 0, v15
    v_cvt_pk_bf16_f32 v8, v8, v9
    v_cvt_pk_bf16_f32 v9, v10, v11
    v_cvt_pk_bf16_f32 v10, v12, v13
    s_waitcnt lgkmcnt(6)
    v_mfma_f32_32x32x16_bf16 v[24:39], v[176:179], v[48:51], v[24:39]
    ds_read_b128 v[44:47], v5 offset:14336
    v_cvt_pk_bf16_f32 v11, v14, v15
    s_waitcnt lgkmcnt(2)
    v_fma_f32 v16, -v60, v152, v16
    v_fma_f32 v17, -v60, v153, v17
    v_fma_f32 v18, -v60, v154, v18
    v_fma_f32 v19, -v60, v155, v19
    v_fma_f32 v20, -v60, v156, v20
    v_mfma_f32_32x32x16_bf16 v[24:39], v[180:183], v[52:55], v[24:39]
    ds_read_b128 v[48:51], v5 offset:15360
    v_fma_f32 v21, -v60, v157, v21
    v_fma_f32 v22, -v60, v158, v22
    v_fma_f32 v23, -v60, v159, v23
    v_fma_f32 v16, v16, v61, v160
    v_fma_f32 v17, v17, v61, v161
    v_fma_f32 v18, v18, v61, v162
    v_fma_f32 v19, v19, v61, v163
    s_setprio 1
    v_mfma_f32_32x32x16_bf16 v[24:39], v[184:187], v[56:59], v[24:39]
    ds_read_b128 v[52:55], v5 offset:16384
    v_fma_f32 v20, v20, v61, v164
    v_fma_f32 v21, v21, v61, v165
    v_fma_f32 v22, v22, v61, v166
    v_fma_f32 v23, v23, v61, v167
    v_max_f32 v16, 0, v16
    v_max_f32 v17, 0, v17
    v_max_f32 v18, 0, v18
    s_waitcnt lgkmcnt(3)
    v_mfma_f32_32x32x16_bf16 v[24:39], v[188:191], v[40:43], v[24:39]
    ds_read_b128 v[56:59], v5 offset:17408
    v_max_f32 v19, 0, v19
    v_max_f32 v20, 0, v20
    v_max_f32 v21, 0, v21
    v_max_f32 v22, 0, v22
    v_max_f32 v23, 0, v23
    v_cvt_pk_bf16_f32 v12, v16, v17
    v_cvt_pk_bf16_f32 v13, v18, v19
    s_waitcnt lgkmcnt(3)
    v_mfma_f32_32x32x16_bf16 v[24:39], v[192:195], v[44:47], v[24:39]
    ds_read_b128 v[40:43], v5 offset:18432
    v_cvt_pk_bf16_f32 v14, v20, v21
    v_cvt_pk_bf16_f32 v15, v22, v23
    buffer_store_dwordx4 v[8:11], v1, s[36:39], s72 offen offset:0 sc1
    buffer_store_dwordx4 v[12:15], v1, s[36:39], s72 offen offset:1024 sc1
    s_waitcnt lgkmcnt(3)
    v_mfma_f32_32x32x16_bf16 v[24:39], v[196:199], v[48:51], v[24:39]
    ds_read_b128 v[44:47], v5 offset:19456
    s_waitcnt lgkmcnt(3)
    v_mfma_f32_32x32x16_bf16 v[24:39], v[200:203], v[52:55], v[24:39]
    ds_read_b128 v[48:51], v5 offset:20480
    s_waitcnt lgkmcnt(3)
    v_mfma_f32_32x32x16_bf16 v[24:39], v[204:207], v[56:59], v[24:39]
    ds_read_b128 v[52:55], v5 offset:21504
    s_waitcnt lgkmcnt(3)
    v_mfma_f32_32x32x16_bf16 v[24:39], v[208:211], v[40:43], v[24:39]
    ds_read_b128 v[56:59], v5 offset:22528
    s_waitcnt lgkmcnt(3)
    v_mfma_f32_32x32x16_bf16 v[24:39], v[212:215], v[44:47], v[24:39]
    ds_read_b128 v[40:43], v5 offset:23552
    s_add_u32 s78, s79, 0
    buffer_load_dwordx4 v[136:139], v1, s[36:39], s78 offen offset:0 sc1
    s_waitcnt lgkmcnt(3)
    v_mfma_f32_32x32x16_bf16 v[24:39], v[216:219], v[48:51], v[24:39]
    ds_read_b128 v[44:47], v5 offset:24576
    ds_read_b128 v[168:171], v4
    buffer_load_dwordx4 v[140:143], v1, s[36:39], s78 offen offset:1024 sc1
    s_waitcnt lgkmcnt(4)
    v_mfma_f32_32x32x16_bf16 v[24:39], v[220:223], v[52:55], v[24:39]
    ds_read_b128 v[48:51], v5 offset:25600
    ds_read_b128 v[172:175], v4 offset:1024
    s_waitcnt lgkmcnt(5)
    v_mfma_f32_32x32x16_bf16 v[24:39], v[224:227], v[56:59], v[24:39]
    ds_read_b128 v[52:55], v5 offset:26624
    ds_read_b128 v[176:179], v4 offset:2048
    ds_read_b128 v[184:187], v2
    s_waitcnt lgkmcnt(7)
    v_mfma_f32_32x32x16_bf16 v[24:39], v[228:231], v[40:43], v[24:39]
    ds_read_b128 v[56:59], v5 offset:27648
    ds_read_b128 v[180:183], v4 offset:3072
    ds_read_b128 v[192:195], v2 offset:64
    s_setprio 0
    s_waitcnt lgkmcnt(9)
    v_mfma_f32_32x32x16_bf16 v[24:39], v[232:235], v[44:47], v[24:39]
    ds_read_b128 v[40:43], v5 offset:28672
    ds_read_b128 v[144:147], v3
    ds_read_b128 v[188:191], v2 offset:16
    s_waitcnt lgkmcnt(10)
    v_mfma_f32_32x32x16_bf16 v[24:39], v[236:239], v[48:51], v[24:39]
    ds_read_b128 v[44:47], v5 offset:29696
    ds_read_b128 v[148:151], v3 offset:1024
    ds_read_b128 v[196:199], v2 offset:80
    s_waitcnt lgkmcnt(11)
    v_mfma_f32_32x32x16_bf16 v[24:39], v[240:243], v[52:55], v[24:39]
    ds_read_b128 v[48:51], v5 offset:30720
    ds_read_b128 v[152:155], v3 offset:2048
    ds_read_b128 v[200:203], v2 offset:32
    s_waitcnt lgkmcnt(11)
    v_mfma_f32_32x32x16_bf16 v[24:39], v[244:247], v[56:59], v[24:39]
    ds_read_b128 v[52:55], v5 offset:31744
    ds_read_b128 v[156:159], v3 offset:3072
    ds_read_b128 v[208:211], v2 offset:96
    s_barrier
    s_waitcnt lgkmcnt(11)
    v_mfma_f32_32x32x16_bf16 v[24:39], v[248:251], v[40:43], v[24:39]
    ds_read_b128 v[160:163], v3 offset:4096
    ds_read_b128 v[204:207], v2 offset:48
    buffer_load_dwordx4 v[216:219], v1, s[36:39], s28 offen offset:0 sc1
    s_waitcnt lgkmcnt(10)
    v_mfma_f32_32x32x16_bf16 v[24:39], v[252:255], v[44:47], v[24:39]
    ds_read_b128 v[164:167], v3 offset:5120
    ds_read_b128 v[212:215], v2 offset:112
    buffer_load_dwordx4 v[220:223], v1, s[36:39], s28 offen offset:1024 sc1
    s_waitcnt lgkmcnt(9)
    v_mfma_f32_32x32x16_bf16 v[24:39], v[64:67], v[48:51], v[24:39]
    buffer_load_dwordx4 v[224:227], v1, s[36:39], s28 offen offset:2048 sc1
    s_waitcnt lgkmcnt(6)
    v_mfma_f32_32x32x16_bf16 v[24:39], v[68:71], v[52:55], v[24:39]
    buffer_load_dwordx4 v[228:231], v1, s[36:39], s28 offen offset:3072 sc1
    s_setprio 3
    s_add_u32 s28, s28, 4096
    buffer_load_dwordx4 v[232:235], v1, s[36:39], s28 offen offset:0 sc1
    buffer_load_dwordx4 v[236:239], v1, s[36:39], s28 offen offset:1024 sc1
    s_nop 6
    v_fma_f32 v24, -v62, v184, v24
    v_fma_f32 v25, -v62, v185, v25
    v_fma_f32 v26, -v62, v186, v26
    v_fma_f32 v27, -v62, v187, v27
    v_fma_f32 v28, -v62, v188, v28
    v_fma_f32 v29, -v62, v189, v29
    v_fma_f32 v30, -v62, v190, v30
    v_fma_f32 v31, -v62, v191, v31
    v_fma_f32 v24, v24, v63, v192
    v_fma_f32 v25, v25, v63, v193
    v_fma_f32 v26, v26, v63, v194
    v_fma_f32 v27, v27, v63, v195
    v_fma_f32 v28, v28, v63, v196
    v_fma_f32 v29, v29, v63, v197
    v_fma_f32 v30, v30, v63, v198
    v_fma_f32 v31, v31, v63, v199
    v_max_f32 v24, 0, v24
    v_max_f32 v25, 0, v25
    v_max_f32 v26, 0, v26
    v_max_f32 v27, 0, v27
    v_max_f32 v28, 0, v28
    v_max_f32 v29, 0, v29
    v_max_f32 v30, 0, v30
    v_max_f32 v31, 0, v31
    v_cvt_pk_bf16_f32 v24, v24, v25
    v_cvt_pk_bf16_f32 v25, v26, v27
    v_cvt_pk_bf16_f32 v26, v28, v29
    v_cvt_pk_bf16_f32 v27, v30, v31
    s_waitcnt lgkmcnt(0)
    v_fma_f32 v32, -v62, v200, v32
    v_fma_f32 v33, -v62, v201, v33
    v_fma_f32 v34, -v62, v202, v34
    v_fma_f32 v35, -v62, v203, v35
    v_fma_f32 v36, -v62, v204, v36
    v_fma_f32 v37, -v62, v205, v37
    v_fma_f32 v38, -v62, v206, v38
    v_fma_f32 v39, -v62, v207, v39
    v_fma_f32 v32, v32, v63, v208
    v_fma_f32 v33, v33, v63, v209
    v_fma_f32 v34, v34, v63, v210
    v_fma_f32 v35, v35, v63, v211
    v_fma_f32 v36, v36, v63, v212
    v_fma_f32 v37, v37, v63, v213
    v_fma_f32 v38, v38, v63, v214
    v_fma_f32 v39, v39, v63, v215
    v_max_f32 v32, 0, v32
    v_max_f32 v33, 0, v33
    v_max_f32 v34, 0, v34
    v_max_f32 v35, 0, v35
    v_max_f32 v36, 0, v36
    v_max_f32 v37, 0, v37
    v_max_f32 v38, 0, v38
    v_max_f32 v39, 0, v39
    v_cvt_pk_bf16_f32 v28, v32, v33
    v_cvt_pk_bf16_f32 v29, v34, v35
    v_cvt_pk_bf16_f32 v30, v36, v37
    v_cvt_pk_bf16_f32 v31, v38, v39
    buffer_store_dwordx4 v[24:27], v1, s[36:39], s73 offen offset:0 sc1
    buffer_store_dwordx4 v[28:31], v1, s[36:39], s73 offen offset:1024 sc1
L_p4done:
    v_and_b32 v2, 15, v0
    v_lshlrev_b32 v3, 3, v2
    s_lshl_b32 s48, s85, 7
    s_add_u32 s49, s48, 68608
    v_add_u32 v3, s49, v3
    ds_read_b64 v[64:65], v3
    v_lshrrev_b32 v3, 5, v0
    v_and_b32 v5, 16, v0
    v_add_u32 v3, v3, v5
    v_lshlrev_b32 v5, 10, v3
    v_lshl_add_u32 v5, v2, 3, v5
    v_lshrrev_b32 v66, 1, v2
    v_lshlrev_b32 v66, 9, v66
    v_lshl_add_u32 v66, v3, 4, v66
    v_and_b32 v67, 1, v2
    v_lshl_add_u32 v66, v67, 3, v66
    v_mul_u32_u24 v4, 528, v2
    v_lshl_add_u32 v4, v3, 4, v4
    s_lshl_b32 s48, s5, 5
    v_add_u32 v4, s48, v4
    v_lshrrev_b32 v2, 5, v0
    v_lshlrev_b32 v2, 4, v2
    v_add_u32 v2, v2, v1
    s_mul_i32 s48, s5, 8448
    v_add_u32 v2, s48, v2
    v_add_u32 v3, 67584, v2
    s_waitcnt lgkmcnt(0)
    s_barrier
    s_waitcnt lgkmcnt(0)
    v_add_u32 v6, 67584, v4
    s_waitcnt vmcnt(5)
L_chk_140:
    v_cmp_eq_u32 vcc, -1, v216
    s_nop 0
    s_cmp_lg_u64 vcc, 0
    s_cbranch_scc1 L_rty_141
L_ok_142:
    v_mfma_f32_32x32x16_bf16 v[8:23], v[136:139], v[216:219], 0
    v_mfma_f32_32x32x16_bf16 v[24:39], v[140:143], v[216:219], 0
    buffer_load_dwordx4 v[184:187], v1, s[36:39], s28 offen offset:2048 sc1
    s_waitcnt vmcnt(5)
L_chk_143:
    v_cmp_eq_u32 vcc, -1, v220
    s_nop 0
    s_cmp_lg_u64 vcc, 0
    s_cbranch_scc1 L_rty_144
L_ok_145:
    v_mfma_f32_32x32x16_bf16 v[8:23], v[144:147], v[220:223], v[8:23]
    v_mfma_f32_32x32x16_bf16 v[24:39], v[148:151], v[220:223], v[24:39]
    buffer_load_dwordx4 v[188:191], v1, s[36:39], s28 offen offset:3072 sc1
    s_waitcnt vmcnt(5)
L_chk_146:
    v_cmp_eq_u32 vcc, -1, v224
    s_nop 0
    s_cmp_lg_u64 vcc, 0
    s_cbranch_scc1 L_rty_147
L_ok_148:
    v_mfma_f32_32x32x16_bf16 v[8:23], v[152:155], v[224:227], v[8:23]
    v_mfma_f32_32x32x16_bf16 v[24:39], v[156:159], v[224:227], v[24:39]
    s_add_u32 s28, s28, 4096
    buffer_load_dwordx4 v[192:195], v1, s[36:39], s28 offen offset:0 sc1
    s_waitcnt vmcnt(5)
L_chk_149:
    v_cmp_eq_u32 vcc, -1, v228
    s_nop 0
    s_cmp_lg_u64 vcc, 0
    s_cbranch_scc1 L_rty_150
L_ok_151:
    v_mfma_f32_32x32x16_bf16 v[8:23], v[160:163], v[228:231], v[8:23]
    v_mfma_f32_32x32x16_bf16 v[24:39], v[164:167], v[228:231], v[24:39]
    buffer_load_dwordx4 v[196:199], v1, s[36:39], s28 offen offset:1024 sc1
    s_waitcnt vmcnt(5)
L_chk_152:
    v_cmp_eq_u32 vcc, -1, v232
    s_nop 0
    s_cmp_lg_u64 vcc, 0
    s_cbranch_scc1 L_rty_153
L_ok_154:
    v_mfma_f32_32x32x16_bf16 v[8:23], v[168:171], v[232:235], v[8:23]
    v_mfma_f32_32x32x16_bf16 v[24:39], v[172:175], v[232:235], v[24:39]
    buffer_load_dwordx4 v[200:203], v1, s[36:39], s28 offen offset:2048 sc1
    s_waitcnt vmcnt(5)
L_chk_155:
    v_cmp_eq_u32 vcc, -1, v236
    s_nop 0
    s_cmp_lg_u64 vcc, 0
    s_cbranch_scc1 L_rty_156
L_ok_157:
    v_mfma_f32_32x32x16_bf16 v[8:23], v[176:179], v[236:239], v[8:23]
    v_mfma_f32_32x32x16_bf16 v[24:39], v[180:183], v[236:239], v[24:39]
    buffer_load_dwordx4 v[204:207], v1, s[36:39], s28 offen offset:3072 sc1
    s_waitcnt vmcnt(5)
L_chk_158:
    v_cmp_eq_u32 vcc, -1, v184
    s_nop 0
    s_cmp_lg_u64 vcc, 0
    s_cbranch_scc1 L_rty_159
L_ok_160:
    v_mfma_f32_32x32x16_bf16 v[8:23], v[72:75], v[184:187], v[8:23]
    v_mfma_f32_32x32x16_bf16 v[24:39], v[76:79], v[184:187], v[24:39]
    s_add_u32 s28, s28, 4096
    buffer_load_dwordx4 v[208:211], v1, s[36:39], s28 offen offset:0 sc1
    s_waitcnt vmcnt(5)
L_chk_161:
    v_cmp_eq_u32 vcc, -1, v188
    s_nop 0
    s_cmp_lg_u64 vcc, 0
    s_cbranch_scc1 L_rty_162
L_ok_163:
    v_mfma_f32_32x32x16_bf16 v[8:23], v[80:83], v[188:191], v[8:23]
    v_mfma_f32_32x32x16_bf16 v[24:39], v[84:87], v[188:191], v[24:39]
    buffer_load_dwordx4 v[212:215], v1, s[36:39], s28 offen offset:1024 sc1
    s_waitcnt vmcnt(5)
L_chk_164:
    v_cmp_eq_u32 vcc, -1, v192
    s_nop 0
    s_cmp_lg_u64 vcc, 0
    s_cbranch_scc1 L_rty_165
L_ok_166:
    v_mfma_f32_32x32x16_bf16 v[8:23], v[88:91], v[192:195], v[8:23]
    v_mfma_f32_32x32x16_bf16 v[24:39], v[92:95], v[192:195], v[24:39]
    buffer_load_dwordx4 v[240:243], v1, s[36:39], s28 offen offset:2048 sc1
    buffer_load_dwordx2 v[68:69], v66, s[36:39], s31 offen sc1
    buffer_load_dwordx2 v[70:71], v66, s[36:39], s18 offen sc1
    s_waitcnt vmcnt(7)
L_chk_167:
    v_cmp_eq_u32 vcc, -1, v196
    s_nop 0
    s_cmp_lg_u64 vcc, 0
    s_cbranch_scc1 L_rty_168
L_ok_169:
    v_mfma_f32_32x32x16_bf16 v[8:23], v[96:99], v[196:199], v[8:23]
    v_mfma_f32_32x32x16_bf16 v[24:39], v[100:103], v[196:199], v[24:39]
    buffer_load_dwordx4 v[244:247], v1, s[36:39], s28 offen offset:3072 sc1
    s_waitcnt vmcnt(7)
L_chk_170:
    v_cmp_eq_u32 vcc, -1, v200
    s_nop 0
    s_cmp_lg_u64 vcc, 0
    s_cbranch_scc1 L_rty_171
L_ok_172:
    v_mfma_f32_32x32x16_bf16 v[8:23], v[104:107], v[200:203], v[8:23]
    v_mfma_f32_32x32x16_bf16 v[24:39], v[108:111], v[200:203], v[24:39]
    s_add_u32 s28, s28, 4096
    buffer_load_dwordx4 v[248:251], v1, s[36:39], s28 offen offset:0 sc1
    s_waitcnt vmcnt(7)
L_chk_173:
    v_cmp_eq_u32 vcc, -1, v204
    s_nop 0
    s_cmp_lg_u64 vcc, 0
    s_cbranch_scc1 L_rty_174
L_ok_175:
    v_mfma_f32_32x32x16_bf16 v[8:23], v[112:115], v[204:207], v[8:23]
    v_mfma_f32_32x32x16_bf16 v[24:39], v[116:119], v[204:207], v[24:39]
    buffer_load_dwordx4 v[252:255], v1, s[36:39], s28 offen offset:1024 sc1
    s_waitcnt vmcnt(7)
L_chk_176:
    v_cmp_eq_u32 vcc, -1, v208
    s_nop 0
    s_cmp_lg_u64 vcc, 0
    s_cbranch_scc1 L_rty_177
L_ok_178:
    v_mfma_f32_32x32x16_bf16 v[8:23], v[120:123], v[208:211], v[8:23]
    v_mfma_f32_32x32x16_bf16 v[24:39], v[124:127], v[208:211], v[24:39]
    buffer_load_dwordx4 v[40:43], v1, s[36:39], s28 offen offset:2048 sc1
    s_waitcnt vmcnt(7)
L_chk_179:
    v_cmp_eq_u32 vcc, -1, v212
    s_nop 0
    s_cmp_lg_u64 vcc, 0
    s_cbranch_scc1 L_rty_180
L_ok_181:
    v_mfma_f32_32x32x16_bf16 v[8:23], v[128:131], v[212:215], v[8:23]
    v_mfma_f32_32x32x16_bf16 v[24:39], v[132:135], v[212:215], v[24:39]
    buffer_load_dwordx4 v[44:47], v1, s[36:39], s28 offen offset:3072 sc1
    s_waitcnt vmcnt(7)
L_chk_182:
    v_cmp_eq_u32 vcc, -1, v240
    s_nop 0
    s_cmp_lg_u64 vcc, 0
    s_cbranch_scc1 L_rty_183
L_ok_184:
    v_mfma_f32_32x32x16_bf16 v[184:199], v[136:139], v[240:243], 0
    v_mfma_f32_32x32x16_bf16 v[200:215], v[140:143], v[240:243], 0
    s_add_u32 s28, s28, 4096
    buffer_load_dwordx4 v[48:51], v1, s[36:39], s28 offen offset:0 sc1
    s_waitcnt vmcnt(5)
L_chk_185:
    v_cmp_eq_u32 vcc, -1, v244
    s_nop 0
    s_cmp_lg_u64 vcc, 0
    s_cbranch_scc1 L_rty_186
L_ok_187:
    v_mfma_f32_32x32x16_bf16 v[184:199], v[144:147], v[244:247], v[184:199]
    v_mfma_f32_32x32x16_bf16 v[200:215], v[148:151], v[244:247], v[200:215]
    buffer_load_dwordx4 v[52:55], v1, s[36:39], s28 offen offset:1024 sc1
    ds_write_b128 v2, v[8:11]
    ds_write_b128 v2, v[12:15] offset:1056
    s_waitcnt vmcnt(5)
L_chk_188:
    v_cmp_eq_u32 vcc, -1, v248
    s_nop 0
    s_cmp_lg_u64 vcc, 0
    s_cbranch_scc1 L_rty_189
L_ok_190:
    v_mfma_f32_32x32x16_bf16 v[184:199], v[152:155], v[248:251], v[184:199]
    v_mfma_f32_32x32x16_bf16 v[200:215], v[156:159], v[248:251], v[200:215]
    buffer_load_dwordx4 v[56:59], v1, s[36:39], s28 offen offset:2048 sc1
    ds_write_b128 v2, v[16:19] offset:2112
    ds_write_b128 v2, v[20:23] offset:3168
    s_waitcnt vmcnt(5)
L_chk_191:
    v_cmp_eq_u32 vcc, -1, v252
    s_nop 0
    s_cmp_lg_u64 vcc, 0
    s_cbranch_scc1 L_rty_192
L_ok_193:
    v_mfma_f32_32x32x16_bf16 v[184:199], v[160:163], v[252:255], v[184:199]
    v_mfma_f32_32x32x16_bf16 v[200:215], v[164:167], v[252:255], v[200:215]
    buffer_load_dwordx4 v[60:63], v1, s[36:39], s28 offen offset:3072 sc1
    ds_write_b128 v2, v[24:27] offset:4224
    ds_write_b128 v2, v[28:31] offset:5280
    s_waitcnt vmcnt(5)
L_chk_194:
    v_cmp_eq_u32 vcc, -1, v40
    s_nop 0
    s_cmp_lg_u64 vcc, 0
    s_cbranch_scc1 L_rty_195
L_ok_196:
    v_mfma_f32_32x32x16_bf16 v[184:199], v[168:171], v[40:43], v[184:199]
    v_mfma_f32_32x32x16_bf16 v[200:215], v[172:175], v[40:43], v[200:215]
    s_add_u32 s28, s28, 4096
    buffer_load_dwordx4 v[216:219], v1, s[36:39], s28 offen offset:0 sc1
    ds_write_b128 v2, v[32:35] offset:6336
    ds_write_b128 v2, v[36:39] offset:7392
    s_waitcnt vmcnt(5)
L_chk_197:
    v_cmp_eq_u32 vcc, -1, v44
    s_nop 0
    s_cmp_lg_u64 vcc, 0
    s_cbranch_scc1 L_rty_198
L_ok_199:
    v_mfma_f32_32x32x16_bf16 v[184:199], v[176:179], v[44:47], v[184:199]
    v_mfma_f32_32x32x16_bf16 v[200:215], v[180:183], v[44:47], v[200:215]
    buffer_load_dwordx4 v[220:223], v1, s[36:39], s28 offen offset:1024 sc1
    s_waitcnt vmcnt(5)
L_chk_200:
    v_cmp_eq_u32 vcc, -1, v48
    s_nop 0
    s_cmp_lg_u64 vcc, 0
    s_cbranch_scc1 L_rty_201
L_ok_202:
    v_mfma_f32_32x32x16_bf16 v[184:199], v[72:75], v[48:51], v[184:199]
    v_mfma_f32_32x32x16_bf16 v[200:215], v[76:79], v[48:51], v[200:215]
    buffer_load_dwordx4 v[224:227], v1, s[36:39], s28 offen offset:2048 sc1
L_ck_203:
    s_waitcnt lgkmcnt(0)
    v_max_u32 v232, v68, v70
    v_cmp_eq_u32 vcc, -1, v232
    s_cbranch_vccnz L_cr_204
L_cd_205:
    v_and_b32 v233, 4294901760, v64
    v_lshlrev_b32 v232, 16, v64
    v_and_b32 v235, 4294901760, v65
    v_lshlrev_b32 v234, 16, v65
    v_and_b32 v237, 4294901760, v68
    v_lshlrev_b32 v236, 16, v68
    v_and_b32 v239, 4294901760, v69
    v_lshlrev_b32 v238, 16, v69
    s_waitcnt vmcnt(5)
L_chk_208:
    v_cmp_eq_u32 vcc, -1, v52
    s_nop 0
    s_cmp_lg_u64 vcc, 0
    s_cbranch_scc1 L_rty_209
L_ok_210:
    v_mfma_f32_32x32x16_bf16 v[184:199], v[80:83], v[52:55], v[184:199]
    v_mfma_f32_32x32x16_bf16 v[200:215], v[84:87], v[52:55], v[200:215]
    buffer_load_dwordx4 v[228:231], v1, s[36:39], s28 offen offset:3072 sc1
    s_waitcnt lgkmcnt(0)
    s_barrier
    ds_read_b128 v[8:11], v4
    ds_read_b128 v[12:15], v4 offset:8448
    s_waitcnt vmcnt(5)
L_chk_211:
    v_cmp_eq_u32 vcc, -1, v56
    s_nop 0
    s_cmp_lg_u64 vcc, 0
    s_cbranch_scc1 L_rty_212
L_ok_213:
    v_mfma_f32_32x32x16_bf16 v[184:199], v[88:91], v[56:59], v[184:199]
    ds_read_b128 v[16:19], v4 offset:16896
    ds_read_b128 v[20:23], v4 offset:25344
    s_waitcnt vmcnt(4)
L_chk_214:
    v_cmp_eq_u32 vcc, -1, v60
    s_nop 0
    s_cmp_lg_u64 vcc, 0
    s_cbranch_scc1 L_rty_215
L_ok_216:
    v_mfma_f32_32x32x16_bf16 v[184:199], v[96:99], v[60:63], v[184:199]
    ds_read_b128 v[24:27], v4 offset:33792
    ds_read_b128 v[28:31], v4 offset:42240
    s_waitcnt vmcnt(3)
L_chk_217:
    v_cmp_eq_u32 vcc, -1, v216
    s_nop 0
    s_cmp_lg_u64 vcc, 0
    s_cbranch_scc1 L_rty_218
L_ok_219:
    v_mfma_f32_32x32x16_bf16 v[184:199], v[104:107], v[216:219], v[184:199]
    ds_read_b128 v[32:35], v4 offset:50688
    ds_read_b128 v[36:39], v4 offset:59136
    s_waitcnt vmcnt(2)
L_chk_220:
    v_cmp_eq_u32 vcc, -1, v220
    s_nop 0
    s_cmp_lg_u64 vcc, 0
    s_cbranch_scc1 L_rty_221
L_ok_222:
    v_mfma_f32_32x32x16_bf16 v[184:199], v[112:115], v[220:223], v[184:199]
    s_waitcnt vmcnt(1)
L_chk_223:
    v_cmp_eq_u32 vcc, -1, v224
    s_nop 0
    s_cmp_lg_u64 vcc, 0
    s_cbranch_scc1 L_rty_224
L_ok_225:
    v_mfma_f32_32x32x16_bf16 v[184:199], v[120:123], v[224:227], v[184:199]
    s_waitcnt vmcnt(0)
L_chk_226:
    v_cmp_eq_u32 vcc, -1, v228
    s_nop 0
    s_cmp_lg_u64 vcc, 0
    s_cbranch_scc1 L_rty_227
L_ok_228:
    v_mfma_f32_32x32x16_bf16 v[184:199], v[128:131], v[228:231], v[184:199]
    v_mfma_f32_32x32x16_bf16 v[200:215], v[92:95], v[56:59], v[200:215]
    s_waitcnt lgkmcnt(0)
    v_add_f32 v8, v8, v24
    v_add_f32 v9, v9, v25
    v_add_f32 v10, v10, v26
    v_add_f32 v11, v11, v27
    v_add_f32 v12, v12, v28
    v_mfma_f32_32x32x16_bf16 v[200:215], v[100:103], v[60:63], v[200:215]
    v_add_f32 v13, v13, v29
    v_add_f32 v14, v14, v30
    v_add_f32 v15, v15, v31
    v_add_f32 v16, v16, v32
    v_add_f32 v17, v17, v33
    v_add_f32 v18, v18, v34
    ds_write_b128 v3, v[184:187]
    v_mfma_f32_32x32x16_bf16 v[200:215], v[108:111], v[216:219], v[200:215]
    v_add_f32 v19, v19, v35
    v_add_f32 v20, v20, v36
    v_add_f32 v21, v21, v37
    v_add_f32 v22, v22, v38
    v_add_f32 v23, v23, v39
    v_add_f32 v8, v8, v16
    ds_write_b128 v3, v[188:191] offset:1056
    v_mfma_f32_32x32x16_bf16 v[200:215], v[116:119], v[220:223], v[200:215]
    v_add_f32 v9, v9, v17
    v_add_f32 v10, v10, v18
    v_add_f32 v11, v11, v19
    v_add_f32 v12, v12, v20
    v_add_f32 v13, v13, v21
    v_add_f32 v14, v14, v22
    ds_write_b128 v3, v[192:195] offset:2112
    v_mfma_f32_32x32x16_bf16 v[200:215], v[124:127], v[224:227], v[200:215]
    v_add_f32 v15, v15, v23
    v_add_f32 v8, v8, v12
    v_add_f32 v9, v9, v13
    v_add_f32 v10, v10, v14
    v_add_f32 v11, v11, v15
    v_fma_f32 v8, v8, v232, v236
    ds_write_b128 v3, v[196:199] offset:3168
    v_mfma_f32_32x32x16_bf16 v[200:215], v[132:135], v[228:231], v[200:215]
    v_fma_f32 v9, v9, v233, v237
    v_fma_f32 v10, v10, v234, v238
    v_fma_f32 v11, v11, v235, v239
    v_cvt_pk_bf16_f32 v8, v8, v9
    v_cvt_pk_bf16_f32 v9, v10, v11
    buffer_store_dwordx2 v[8:9], v5, s[32:35], s30 offen sc1
    s_add_u32 s30, s30, 32768
    v_and_b32 v237, 4294901760, v70
    v_lshlrev_b32 v236, 16, v70
    v_and_b32 v239, 4294901760, v71
    v_lshlrev_b32 v238, 16, v71
    s_nop 0
    ds_write_b128 v3, v[200:203] offset:4224
    ds_write_b128 v3, v[204:207] offset:5280
    ds_write_b128 v3, v[208:211] offset:6336
    ds_write_b128 v3, v[212:215] offset:7392
    s_waitcnt lgkmcnt(0)
    s_barrier
    ds_read_b128 v[104:107], v6
    ds_read_b128 v[108:111], v6 offset:8448
    ds_read_b128 v[112:115], v6 offset:16896
    ds_read_b128 v[116:119], v6 offset:25344
    ds_read_b128 v[120:123], v6 offset:33792
    ds_read_b128 v[124:127], v6 offset:42240
    ds_read_b128 v[128:131], v6 offset:50688
    ds_read_b128 v[132:135], v6 offset:59136
    s_waitcnt lgkmcnt(6)
    v_add_f32 v104, v104, v108
    v_add_f32 v105, v105, v109
    v_add_f32 v106, v106, v110
    v_add_f32 v107, v107, v111
    s_waitcnt lgkmcnt(4)
    v_add_f32 v112, v112, v116
    v_add_f32 v113, v113, v117
    v_add_f32 v114, v114, v118
    v_add_f32 v115, v115, v119
    v_add_f32 v104, v104, v112
    v_add_f32 v105, v105, v113
    v_add_f32 v106, v106, v114
    v_add_f32 v107, v107, v115
    s_waitcnt lgkmcnt(2)
    v_add_f32 v120, v120, v124
    v_add_f32 v121, v121, v125
    v_add_f32 v122, v122, v126
    v_add_f32 v123, v123, v127
    s_waitcnt lgkmcnt(0)
    v_add_f32 v128, v128, v132
    v_add_f32 v129, v129, v133
    v_add_f32 v130, v130, v134
    v_add_f32 v131, v131, v135
    v_add_f32 v120, v120, v128
    v_add_f32 v121, v121, v129
    v_add_f32 v122, v122, v130
    v_add_f32 v123, v123, v131
    v_add_f32 v104, v104, v120
    v_add_f32 v105, v105, v121
    v_add_f32 v106, v106, v122
    v_add_f32 v107, v107, v123
    v_fma_f32 v104, v104, v232, v236
    v_fma_f32 v105, v105, v233, v237
    v_fma_f32 v106, v106, v234, v238
    v_fma_f32 v107, v107, v235, v239
    v_cvt_pk_bf16_f32 v104, v104, v105
    v_cvt_pk_bf16_f32 v105, v106, v107
    buffer_store_dwordx2 v[104:105], v5, s[32:35], s30 offen sc1
    s_or_b32 s48, s2, s5
    s_cbranch_scc1 L_end
    v_mov_b32 v2, s40
    v_mov_b32 v3, 0
    s_mov_b32 s48, 12288
    s_mov_b64 exec, 1
    buffer_store_dword v2, v3, s[36:39], s48 offen sc1
    s_endpgm
L_slow:
    v_and_b32 v3, 240, v1
    v_lshrrev_b32 v2, 5, v0
    v_lshl_add_u32 v3, v2, 8, v3
    s_lshl_b32 s53, s4, 17
    s_add_u32 s53, s53, 2097152
    s_mov_b32 s54, 0
    v_mov_b32 v2, 4286578688
L_slow1:
    s_add_u32 s55, s53, s54
    buffer_load_dwordx4 v[12:15], v1, s[36:39], s55 offen sc1
    s_waitcnt vmcnt(0)
    v_mfma_f32_32x32x16_bf16 v[40:55], v[12:15], v[8:11], 0
    s_nop 11
    v_max3_f32 v2, v2, v40, v41
    v_max3_f32 v2, v2, v42, v43
    v_max3_f32 v2, v2, v44, v45
    v_max3_f32 v2, v2, v46, v47
    v_max3_f32 v2, v2, v48, v49
    v_max3_f32 v2, v2, v50, v51
    v_max3_f32 v2, v2, v52, v53
    v_max3_f32 v2, v2, v54, v55
    s_add_u32 s54, s54, 2048
    s_cmp_lt_u32 s54, 131072
    s_cbranch_scc1 L_slow1
    v_mov_b32 v56, v2
    s_nop 1
    v_permlane32_swap_b32 v2, v56
    v_max_f32 v2, v2, v56
    v_sub_f32 v56, 0, v2
    v_sub_f32 v57, 0, v2
    v_sub_f32 v58, 0, v2
    v_sub_f32 v59, 0, v2
    v_sub_f32 v60, 0, v2
    v_sub_f32 v61, 0, v2
    v_sub_f32 v62, 0, v2
    v_sub_f32 v63, 0, v2
    v_sub_f32 v64, 0, v2
    v_sub_f32 v65, 0, v2
    v_sub_f32 v66, 0, v2
    v_sub_f32 v67, 0, v2
    v_sub_f32 v68, 0, v2
    v_sub_f32 v69, 0, v2
    v_sub_f32 v70, 0, v2
    v_sub_f32 v71, 0, v2
    v_mov_b32 v24, 0
    v_mov_b32 v25, 0
    v_mov_b32 v26, 0
    v_mov_b32 v27, 0
    v_mov_b32 v28, 0
    v_mov_b32 v29, 0
    v_mov_b32 v30, 0
    v_mov_b32 v31, 0
    v_mov_b32 v32, 0
    v_mov_b32 v33, 0
    v_mov_b32 v34, 0
    v_mov_b32 v35, 0
    v_mov_b32 v36, 0
    v_mov_b32 v37, 0
    v_mov_b32 v38, 0
    v_mov_b32 v39, 0
    s_mov_b32 s54, 0
L_slow2:
    s_add_u32 s55, s53, s54
    buffer_load_dwordx4 v[12:15], v1, s[36:39], s55 offen sc1
    s_mov_b64 exec, s[10:11]
    buffer_load_dwordx4 v[16:19], v3, s[36:39], s55 offen offset:1024 sc1
    buffer_load_dwordx4 v[20:23], v3, s[36:39], s55 offen offset:1536 sc1
    s_mov_b64 exec, -1
    s_waitcnt vmcnt(0)
    v_mfma_f32_32x32x16_bf16 v[40:55], v[12:15], v[8:11], v[56:71]
    s_nop 11
    v_exp_f32 v40, v40
    v_exp_f32 v41, v41
    v_exp_f32 v42, v42
    v_exp_f32 v43, v43
    v_exp_f32 v44, v44
    v_exp_f32 v45, v45
    v_exp_f32 v46, v46
    v_exp_f32 v47, v47
    v_exp_f32 v48, v48
    v_exp_f32 v49, v49
    v_exp_f32 v50, v50
    v_exp_f32 v51, v51
    v_exp_f32 v52, v52
    v_exp_f32 v53, v53
    v_exp_f32 v54, v54
    v_exp_f32 v55, v55
    v_cvt_pk_bf16_f32 v40, v40, v41
    v_cvt_pk_bf16_f32 v41, v42, v43
    v_cvt_pk_bf16_f32 v42, v44, v45
    v_cvt_pk_bf16_f32 v43, v46, v47
    v_cvt_pk_bf16_f32 v44, v48, v49
    v_cvt_pk_bf16_f32 v45, v50, v51
    v_cvt_pk_bf16_f32 v46, v52, v53
    v_cvt_pk_bf16_f32 v47, v54, v55
    v_mfma_f32_32x32x16_bf16 v[24:39], v[16:19], v[40:43], v[24:39]
    s_nop 0
    v_mfma_f32_32x32x16_bf16 v[24:39], v[20:23], v[44:47], v[24:39]
    s_add_u32 s54, s54, 2048
    s_cmp_lt_u32 s54, 131072
    s_nop 7
    s_cbranch_scc1 L_slow2
    s_nop 7
    s_branch L_norm
L_qwo:
    v_lshrrev_b32 v126, 2, v0
    v_lshlrev_b32 v126, 10, v126
    v_and_b32 v2, 48, v1
    v_add_u32 v126, v126, v2
    v_bfe_u32 v2, v0, 2, 3
    v_lshlrev_b32 v127, 6, v2
    s_movk_i32 s75, 32
    s_branch L_qdone
L_publ_9:
    buffer_load_dwordx4 v[32:35], v1, s[36:39], s90 offen sc1
    s_waitcnt vmcnt(0)
    s_call_b64 s[46:47], L_try
    s_cmp_lg_u32 s96, 0
    s_cbranch_scc1 L_pubd_8
    s_mov_b32 s53, s57
    v_lshrrev_b32 v52, 1, v0
    v_lshlrev_b32 v52, 10, v52
    v_and_b32 v32, 16, v1
    v_add_u32 v52, v52, v32
    s_lshl_b32 s56, s0, 15
    s_lshl_b32 s57, s1, 5
    s_add_u32 s56, s56, s57
    s_add_u32 s56, s56, 30408704
    buffer_load_dwordx4 v[32:35], v52, s[36:39], s56 offen sc1
    s_mov_b32 s57, s53
    s_waitcnt vmcnt(0)
    s_call_b64 s[46:47], L_try
    s_cmp_lg_u32 s96, 0
    s_cbranch_scc1 L_pubd_8
    s_add_u32 s8, s8, 1
    s_cmp_lt_u32 s8, 400000
    s_cbranch_scc1 L_publ_9
    s_branch L_pubd_8
L_wpretry:
    s_and_b32 s48, s54, 255
    s_cbranch_scc0 L_wps_10
    s_movk_i32 s50, 0
    s_add_u32 m0, s86, s50
    s_add_u32 s50, s50, s87
    buffer_load_dwordx4 v124, s[36:39], s50 offen sc1 lds
L_wps_10:
    s_and_b32 s48, s54, 65280
    s_cbranch_scc0 L_wps_11
    s_movk_i32 s50, 1024
    s_add_u32 m0, s86, s50
    s_add_u32 s50, s50, s87
    buffer_load_dwordx4 v125, s[36:39], s50 offen sc1 lds
L_wps_11:
    s_and_b32 s48, s54, 16711680
    s_cbranch_scc0 L_wps_12
    s_movk_i32 s50, 2048
    s_add_u32 m0, s86, s50
    s_add_u32 s50, s50, s87
    buffer_load_dwordx4 v124, s[36:39], s50 offen sc1 lds
L_wps_12:
    s_and_b32 s48, s54, 4278190080
    s_cbranch_scc0 L_wps_13
    s_movk_i32 s50, 3072
    s_add_u32 m0, s86, s50
    s_add_u32 s50, s50, s87
    buffer_load_dwordx4 v125, s[36:39], s50 offen sc1 lds
L_wps_13:
    s_and_b32 s48, s55, 255
    s_cbranch_scc0 L_wps_14
    s_movk_i32 s50, 4096
    s_add_u32 m0, s86, s50
    s_add_u32 s50, s50, s87
    buffer_load_dwordx4 v124, s[36:39], s50 offen sc1 lds
L_wps_14:
    s_and_b32 s48, s55, 65280
    s_cbranch_scc0 L_wps_15
    s_movk_i32 s50, 5120
    s_add_u32 m0, s86, s50
    s_add_u32 s50, s50, s87
    buffer_load_dwordx4 v125, s[36:39], s50 offen sc1 lds
L_wps_15:
    s_and_b32 s48, s55, 16711680
    s_cbranch_scc0 L_wps_16
    s_movk_i32 s50, 6144
    s_add_u32 m0, s86, s50
    s_add_u32 s50, s50, s87
    buffer_load_dwordx4 v124, s[36:39], s50 offen sc1 lds
L_wps_16:
    s_and_b32 s48, s55, 4278190080
    s_cbranch_scc0 L_wps_17
    s_movk_i32 s50, 7168
    s_add_u32 m0, s86, s50
    s_add_u32 s50, s50, s87
    buffer_load_dwordx4 v125, s[36:39], s50 offen sc1 lds
L_wps_17:
    s_waitcnt vmcnt(0)
    ds_read_b64 v[40:41], v28 offset:24
    ds_read_b64 v[42:43], v29 offset:8
    s_add_u32 s8, s8, 1
    s_cmp_lt_u32 s8, 400000
    s_cbranch_scc1 L_wpchk
    s_waitcnt lgkmcnt(0)
    s_branch L_wpok
L_rty_19:
    buffer_load_dwordx4 v[112:115], v31, s[36:39], s97 offen offset:0 sc1
    buffer_load_dwordx4 v[116:119], v31, s[36:39], s97 offen offset:256 sc1
    s_waitcnt vmcnt(0)
    s_add_u32 s8, s8, 1
    s_cmp_lt_u32 s8, 400000
    s_cbranch_scc1 L_chk_18
    s_branch L_ok_20
L_w12_21:
    v_lshrrev_b32 v157, 3, v0
    v_mul_u32_u24 v156, 6144, v157
    v_lshlrev_b32 v157, 1, v157
    v_and_b32 v152, 112, v1
    v_add_u32 v156, v156, v152
    s_add_u32 s57, s60, 49152
    buffer_load_dwordx4 v[136:139], v156, s[28:31], s60 offen offset:0 nt
    buffer_load_dwordx4 v[140:143], v156, s[28:31], s57 offen offset:0 nt
    buffer_load_dwordx4 v[144:147], v156, s[28:31], s60 offen offset:1024 nt
    buffer_load_dwordx4 v[148:151], v156, s[28:31], s57 offen offset:1024 nt
    buffer_load_ushort v152, v157, s[24:27], s61 offen offset:0
    buffer_load_ushort v154, v157, s[24:27], s61 offen offset:16
    s_branch L_w12d_22
L_rty_26:
    buffer_load_dwordx2 v[124:125], v4, s[36:39], s64 offen sc1
    s_waitcnt vmcnt(0)
    s_add_u32 s8, s8, 1
    s_cmp_lt_u32 s8, 400000
    s_cbranch_scc1 L_chk_25
    s_branch L_ok_27
L_w12_28:
    s_waitcnt vmcnt(0)
    s_call_b64 s[46:47], L_gemv
    s_branch L_w12d_29
L_pf_30:
    s_lshl_b32 s48, s63, 3
    s_add_u32 s48, s48, 1449984
    s_mov_b64 exec, 1
    buffer_store_dwordx2 v[72:73], v1, s[36:39], s48 offen sc1
    s_mov_b64 exec, -1
    s_branch L_pfd_31
L_rty_34:
    buffer_load_dwordx2 v[124:125], v4, s[36:39], s64 offen sc1
    s_waitcnt vmcnt(0)
    s_add_u32 s8, s8, 1
    s_cmp_lt_u32 s8, 400000
    s_cbranch_scc1 L_chk_33
    s_branch L_ok_35
L_rty_38:
    buffer_load_dwordx2 v[124:125], v4, s[36:39], s64 offen sc1
    s_waitcnt vmcnt(0)
    s_add_u32 s8, s8, 1
    s_cmp_lt_u32 s8, 400000
    s_cbranch_scc1 L_chk_37
    s_branch L_ok_39
L_rty_42:
    buffer_load_dwordx2 v[124:125], v4, s[36:39], s64 offen sc1
    s_waitcnt vmcnt(0)
    s_add_u32 s8, s8, 1
    s_cmp_lt_u32 s8, 400000
    s_cbranch_scc1 L_chk_41
    s_branch L_ok_43
L_w12_44:
    v_lshrrev_b32 v88, 1, v0
    v_lshlrev_b32 v88, 10, v88
    v_and_b32 v84, 16, v1
    v_add_u32 v88, v88, v84
    s_lshl_b32 s56, s0, 15
    s_lshl_b32 s57, s1, 5
    s_add_u32 s56, s56, s57
    s_add_u32 s56, s56, 30408704
    s_lshl_b32 s57, s5, 18
    s_add_u32 s56, s56, s57
    buffer_load_dwordx4 v[84:87], v88, s[36:39], s56 offen sc1
    s_branch L_w12d_45
L_rty_48:
    buffer_load_dwordx2 v[124:125], v4, s[36:39], s64 offen sc1
    s_waitcnt vmcnt(0)
    s_add_u32 s8, s8, 1
    s_cmp_lt_u32 s8, 400000
    s_cbranch_scc1 L_chk_47
    s_branch L_ok_49
L_rty_52:
    buffer_load_dwordx2 v[124:125], v4, s[36:39], s64 offen sc1
    s_waitcnt vmcnt(0)
    s_add_u32 s8, s8, 1
    s_cmp_lt_u32 s8, 400000
    s_cbranch_scc1 L_chk_51
    s_branch L_ok_53
L_rty_57:
    v_lshrrev_b32 v88, 1, v0
    v_lshlrev_b32 v88, 10, v88
    v_and_b32 v84, 16, v1
    v_add_u32 v88, v88, v84
    s_lshl_b32 s56, s0, 15
    s_lshl_b32 s57, s1, 5
    s_add_u32 s56, s56, s57
    s_add_u32 s56, s56, 30408704
    s_lshl_b32 s57, s5, 18
    s_add_u32 s56, s56, s57
    buffer_load_dwordx4 v[84:87], v88, s[36:39], s56 offen sc1
    s_waitcnt vmcnt(0)
    s_add_u32 s8, s8, 1
    s_cmp_lt_u32 s8, 400000
    s_cbranch_scc1 L_chk_56
    s_branch L_ok_58
L_w12_54:
    s_waitcnt vmcnt(9)
L_chk_56:
    v_cmp_ne_u32 vcc, s6, v85
    v_cmp_ne_u32 s[56:57], s7, v87
    s_nop 0
    s_or_b64 vcc, vcc, s[56:57]
    s_cbranch_scc1 L_rty_57
L_ok_58:
    v_add_f32_dpp v85, v84, v84 quad_perm:[2,3,0,1] row_mask:0xf bank_mask:0xf
    v_add_f32_dpp v87, v86, v86 quad_perm:[2,3,0,1] row_mask:0xf bank_mask:0xf
    s_nop 0
    v_add_f32_dpp v84, v85, v85 row_ror:4 row_mask:0xf bank_mask:0xf
    v_add_f32_dpp v86, v87, v87 row_ror:4 row_mask:0xf bank_mask:0xf
    s_nop 0
    v_add_f32_dpp v85, v84, v84 row_ror:8 row_mask:0xf bank_mask:0xf
    v_add_f32_dpp v87, v86, v86 row_ror:8 row_mask:0xf bank_mask:0xf
    s_nop 1
    v_permlane32_swap_b32 v85, v87
    v_add_f32 v88, v85, v87
    v_mov_b32 v84, v88
    s_nop 1
    v_permlane16_swap_b32 v88, v84
    v_add_f32 v88, v88, v84
    s_sub_u32 s48, s5, 1
    s_lshl_b32 s48, s48, 8
    s_add_u32 s48, s48, s63
    s_lshl_b32 s48, s48, 4
    s_add_u32 s48, s48, 1441792
    v_readlane_b32 s50, v88, 0
    v_readlane_b32 s51, v88, 32
    v_readlane_b32 s52, v88, 1
    v_readlane_b32 s53, v88, 33
    v_mov_b32 v93, s6
    v_mov_b32 v95, s7
    v_mov_b32 v88, s50
    v_mov_b32 v89, s51
    v_mov_b32 v90, s52
    v_mov_b32 v91, s53
    v_cvt_pk_bf16_f32 v92, v88, v89
    v_cvt_pk_bf16_f32 v94, v90, v91
    s_mov_b64 exec, 1
    buffer_store_dwordx4 v[92:95], v1, s[36:39], s48 offen sc1
    s_mov_b64 exec, -1
    s_branch L_w12d_55
L_rty_61:
    buffer_load_dwordx4 v[112:115], v1, s[36:39], s78 offen offset:0 sc1
    buffer_load_dwordx4 v[116:119], v1, s[36:39], s78 offen offset:1024 sc1
    s_waitcnt vmcnt(0)
    s_add_u32 s8, s8, 1
    s_cmp_lt_u32 s8, 400000
    s_cbranch_scc1 L_chk_60
    s_branch L_ok_62
L_rty_65:
    buffer_load_dwordx2 v[124:125], v4, s[36:39], s64 offen sc1
    s_waitcnt vmcnt(0)
    s_add_u32 s8, s8, 1
    s_cmp_lt_u32 s8, 400000
    s_cbranch_scc1 L_chk_64
    s_branch L_ok_66
L_rty_71:
    buffer_load_dwordx4 v[112:115], v121, s[36:39], s94 offen sc1
    s_waitcnt vmcnt(0)
    s_add_u32 s8, s8, 1
    s_cmp_lt_u32 s8, 400000
    s_cbranch_scc1 L_chk_70
    s_branch L_ok_72
L_pf_73:
    s_lshl_b32 s48, s63, 3
    s_add_u32 s48, s48, 1454080
    v_mov_b32 v4, s6
    v_mov_b32 v5, s7
    s_mov_b64 exec, 1
    buffer_store_dwordx2 v[4:5], v1, s[36:39], s48 offen sc1
    s_mov_b64 exec, -1
    s_branch L_pfd_74
L_rty_76:
    buffer_load_dwordx4 v[112:115], v1, s[36:39], s78 offen offset:0 sc1
    buffer_load_dwordx4 v[116:119], v1, s[36:39], s78 offen offset:1024 sc1
    s_waitcnt vmcnt(0)
    s_add_u32 s8, s8, 1
    s_cmp_lt_u32 s8, 400000
    s_cbranch_scc1 L_chk_75
    s_branch L_ok_77
L_norm:
    v_rcp_f32 v52, v32
    v_lshrrev_b32 v3, 4, v0
    v_lshlrev_b32 v2, 3, v3
    s_branch L_norm2
L_cr_82:
    v_cmp_eq_u32 vcc, -1, v40
    s_cbranch_vccz L_cs_84
    s_mov_b32 m0, s89
    s_nop 0
    buffer_load_dwordx4 v1, s[36:39], s91 offen offset:0 sc1 lds
L_cs_84:
    v_cmp_eq_u32 vcc, -1, v41
    s_cbranch_vccz L_cs_85
    s_mov_b32 m0, s89
    s_nop 0
    buffer_load_dwordx4 v1, s[36:39], s91 offen offset:1024 sc1 lds
L_cs_85:
    v_cmp_eq_u32 vcc, -1, v42
    s_cbranch_vccz L_cs_86
    s_mov_b32 m0, s89
    s_nop 0
    buffer_load_dwordx4 v1, s[36:39], s91 offen offset:2048 sc1 lds
L_cs_86:
    v_cmp_eq_u32 vcc, -1, v43
    s_cbranch_vccz L_cs_87
    s_mov_b32 m0, s89
    s_nop 0
    buffer_load_dwordx4 v1, s[36:39], s91 offen offset:3072 sc1 lds
L_cs_87:
    s_waitcnt vmcnt(0)
    s_add_u32 s8, s8, 1
    s_cmp_lt_u32 s8, 400000
    s_cbranch_scc1 L_ck_81
    s_branch L_cd_83
L_cr_89:
    v_cmp_eq_u32 vcc, -1, v8
    s_cbranch_vccz L_cs_91
    s_mov_b32 m0, s27
    s_nop 0
    buffer_load_dwordx4 v1, s[36:39], s25 offen offset:0 sc1 lds
L_cs_91:
    v_cmp_eq_u32 vcc, -1, v9
    s_cbranch_vccz L_cs_92
    s_mov_b32 m0, s27
    s_nop 0
    buffer_load_dwordx4 v1, s[36:39], s25 offen offset:1024 sc1 lds
L_cs_92:
    v_cmp_eq_u32 vcc, -1, v10
    s_cbranch_vccz L_cs_93
    s_mov_b32 m0, s27
    s_nop 0
    buffer_load_dwordx4 v1, s[36:39], s25 offen offset:2048 sc1 lds
L_cs_93:
    v_cmp_eq_u32 vcc, -1, v11
    s_cbranch_vccz L_cs_94
    s_mov_b32 m0, s27
    s_nop 0
    buffer_load_dwordx4 v1, s[36:39], s25 offen offset:3072 sc1 lds
L_cs_94:
    s_waitcnt vmcnt(0)
    s_add_u32 s8, s8, 1
    s_cmp_lt_u32 s8, 400000
    s_cbranch_scc1 L_ck_88
    s_branch L_cd_90
L_cr_96:
    v_cmp_eq_u32 vcc, -1, v72
    s_cbranch_vccz L_cs_98
    s_mov_b32 m0, s27
    s_nop 0
    buffer_load_dwordx4 v1, s[36:39], s25 offen offset:0 sc1 lds
L_cs_98:
    v_cmp_eq_u32 vcc, -1, v73
    s_cbranch_vccz L_cs_99
    s_mov_b32 m0, s27
    s_nop 0
    buffer_load_dwordx4 v1, s[36:39], s25 offen offset:1024 sc1 lds
L_cs_99:
    v_cmp_eq_u32 vcc, -1, v74
    s_cbranch_vccz L_cs_100
    s_mov_b32 m0, s27
    s_nop 0
    buffer_load_dwordx4 v1, s[36:39], s25 offen offset:2048 sc1 lds
L_cs_100:
    v_cmp_eq_u32 vcc, -1, v75
    s_cbranch_vccz L_cs_101
    s_mov_b32 m0, s27
    s_nop 0
    buffer_load_dwordx4 v1, s[36:39], s25 offen offset:3072 sc1 lds
L_cs_101:
    s_waitcnt vmcnt(0)
    s_add_u32 s8, s8, 1
    s_cmp_lt_u32 s8, 400000
    s_cbranch_scc1 L_ck_95
    s_branch L_cd_97
L_rty_103:
    s_add_u32 s48, s24, 0
    buffer_load_dwordx4 v[8:11], v1, s[36:39], s48 offen offset:0 sc1
    buffer_load_dwordx4 v[12:15], v1, s[36:39], s48 offen offset:1024 sc1
    buffer_load_dwordx4 v[16:19], v1, s[36:39], s48 offen offset:2048 sc1
    buffer_load_dwordx4 v[20:23], v1, s[36:39], s48 offen offset:3072 sc1
    s_add_u32 s48, s24, 4096
    buffer_load_dwordx4 v[24:27], v1, s[36:39], s48 offen offset:0 sc1
    buffer_load_dwordx4 v[28:31], v1, s[36:39], s48 offen offset:1024 sc1
    buffer_load_dwordx4 v[32:35], v1, s[36:39], s48 offen offset:2048 sc1
    buffer_load_dwordx4 v[36:39], v1, s[36:39], s48 offen offset:3072 sc1
    s_add_u32 s48, s24, 8192
    buffer_load_dwordx4 v[40:43], v1, s[36:39], s48 offen offset:0 sc1
    buffer_load_dwordx4 v[44:47], v1, s[36:39], s48 offen offset:1024 sc1
    buffer_load_dwordx4 v[48:51], v1, s[36:39], s48 offen offset:2048 sc1
    buffer_load_dwordx4 v[52:55], v1, s[36:39], s48 offen offset:3072 sc1
    s_add_u32 s48, s24, 12288
    buffer_load_dwordx4 v[56:59], v1, s[36:39], s48 offen offset:0 sc1
    buffer_load_dwordx4 v[60:63], v1, s[36:39], s48 offen offset:1024 sc1
    buffer_load_dwordx4 v[64:67], v1, s[36:39], s48 offen offset:2048 sc1
    buffer_load_dwordx4 v[68:71], v1, s[36:39], s48 offen offset:3072 sc1
    s_waitcnt vmcnt(0)
    s_add_u32 s8, s8, 1
    s_cmp_lt_u32 s8, 400000
    s_cbranch_scc1 L_chk_102
    s_branch L_ok_104
L_cr_106:
    v_cmp_eq_u32 vcc, -1, v8
    s_cbranch_vccz L_cs_108
    s_add_u32 s48, s26, 0
    s_mov_b32 m0, 106496
    s_nop 0
    buffer_load_dwordx4 v1, s[36:39], s48 offen offset:0 sc1 lds
L_cs_108:
    v_cmp_eq_u32 vcc, -1, v9
    s_cbranch_vccz L_cs_109
    s_add_u32 s48, s26, 0
    s_mov_b32 m0, 106496
    s_nop 0
    buffer_load_dwordx4 v1, s[36:39], s48 offen offset:1024 sc1 lds
L_cs_109:
    v_cmp_eq_u32 vcc, -1, v10
    s_cbranch_vccz L_cs_110
    s_add_u32 s48, s26, 0
    s_mov_b32 m0, 106496
    s_nop 0
    buffer_load_dwordx4 v1, s[36:39], s48 offen offset:2048 sc1 lds
L_cs_110:
    v_cmp_eq_u32 vcc, -1, v11
    s_cbranch_vccz L_cs_111
    s_add_u32 s48, s26, 0
    s_mov_b32 m0, 106496
    s_nop 0
    buffer_load_dwordx4 v1, s[36:39], s48 offen offset:3072 sc1 lds
L_cs_111:
    v_cmp_eq_u32 vcc, -1, v12
    s_cbranch_vccz L_cs_112
    s_add_u32 s48, s26, 4096
    s_mov_b32 m0, 110592
    s_nop 0
    buffer_load_dwordx4 v1, s[36:39], s48 offen offset:0 sc1 lds
L_cs_112:
    v_cmp_eq_u32 vcc, -1, v13
    s_cbranch_vccz L_cs_113
    s_add_u32 s48, s26, 4096
    s_mov_b32 m0, 110592
    s_nop 0
    buffer_load_dwordx4 v1, s[36:39], s48 offen offset:1024 sc1 lds
L_cs_113:
    v_cmp_eq_u32 vcc, -1, v14
    s_cbranch_vccz L_cs_114
    s_add_u32 s48, s26, 4096
    s_mov_b32 m0, 110592
    s_nop 0
    buffer_load_dwordx4 v1, s[36:39], s48 offen offset:2048 sc1 lds
L_cs_114:
    v_cmp_eq_u32 vcc, -1, v15
    s_cbranch_vccz L_cs_115
    s_add_u32 s48, s26, 4096
    s_mov_b32 m0, 110592
    s_nop 0
    buffer_load_dwordx4 v1, s[36:39], s48 offen offset:3072 sc1 lds
L_cs_115:
    v_cmp_eq_u32 vcc, -1, v16
    s_cbranch_vccz L_cs_116
    s_add_u32 s48, s26, 8192
    s_mov_b32 m0, 114688
    s_nop 0
    buffer_load_dwordx4 v1, s[36:39], s48 offen offset:0 sc1 lds
L_cs_116:
    v_cmp_eq_u32 vcc, -1, v17
    s_cbranch_vccz L_cs_117
    s_add_u32 s48, s26, 8192
    s_mov_b32 m0, 114688
    s_nop 0
    buffer_load_dwordx4 v1, s[36:39], s48 offen offset:1024 sc1 lds
L_cs_117:
    v_cmp_eq_u32 vcc, -1, v18
    s_cbranch_vccz L_cs_118
    s_add_u32 s48, s26, 8192
    s_mov_b32 m0, 114688
    s_nop 0
    buffer_load_dwordx4 v1, s[36:39], s48 offen offset:2048 sc1 lds
L_cs_118:
    v_cmp_eq_u32 vcc, -1, v19
    s_cbranch_vccz L_cs_119
    s_add_u32 s48, s26, 8192
    s_mov_b32 m0, 114688
    s_nop 0
    buffer_load_dwordx4 v1, s[36:39], s48 offen offset:3072 sc1 lds
L_cs_119:
    v_cmp_eq_u32 vcc, -1, v20
    s_cbranch_vccz L_cs_120
    s_add_u32 s48, s26, 12288
    s_mov_b32 m0, 118784
    s_nop 0
    buffer_load_dwordx4 v1, s[36:39], s48 offen offset:0 sc1 lds
L_cs_120:
    v_cmp_eq_u32 vcc, -1, v21
    s_cbranch_vccz L_cs_121
    s_add_u32 s48, s26, 12288
    s_mov_b32 m0, 118784
    s_nop 0
    buffer_load_dwordx4 v1, s[36:39], s48 offen offset:1024 sc1 lds
L_cs_121:
    v_cmp_eq_u32 vcc, -1, v22
    s_cbranch_vccz L_cs_122
    s_add_u32 s48, s26, 12288
    s_mov_b32 m0, 118784
    s_nop 0
    buffer_load_dwordx4 v1, s[36:39], s48 offen offset:2048 sc1 lds
L_cs_122:
    v_cmp_eq_u32 vcc, -1, v23
    s_cbranch_vccz L_cs_123
    s_add_u32 s48, s26, 12288
    s_mov_b32 m0, 118784
    s_nop 0
    buffer_load_dwordx4 v1, s[36:39], s48 offen offset:3072 sc1 lds
L_cs_123:
    v_cmp_eq_u32 vcc, -1, v24
    s_cbranch_vccz L_cs_124
    s_add_u32 s48, s26, 16384
    s_mov_b32 m0, 122880
    s_nop 0
    buffer_load_dwordx4 v1, s[36:39], s48 offen offset:0 sc1 lds
L_cs_124:
    v_cmp_eq_u32 vcc, -1, v25
    s_cbranch_vccz L_cs_125
    s_add_u32 s48, s26, 16384
    s_mov_b32 m0, 122880
    s_nop 0
    buffer_load_dwordx4 v1, s[36:39], s48 offen offset:1024 sc1 lds
L_cs_125:
    v_cmp_eq_u32 vcc, -1, v26
    s_cbranch_vccz L_cs_126
    s_add_u32 s48, s26, 16384
    s_mov_b32 m0, 122880
    s_nop 0
    buffer_load_dwordx4 v1, s[36:39], s48 offen offset:2048 sc1 lds
L_cs_126:
    v_cmp_eq_u32 vcc, -1, v27
    s_cbranch_vccz L_cs_127
    s_add_u32 s48, s26, 16384
    s_mov_b32 m0, 122880
    s_nop 0
    buffer_load_dwordx4 v1, s[36:39], s48 offen offset:3072 sc1 lds
L_cs_127:
    v_cmp_eq_u32 vcc, -1, v28
    s_cbranch_vccz L_cs_128
    s_add_u32 s48, s26, 20480
    s_mov_b32 m0, 126976
    s_nop 0
    buffer_load_dwordx4 v1, s[36:39], s48 offen offset:0 sc1 lds
L_cs_128:
    v_cmp_eq_u32 vcc, -1, v29
    s_cbranch_vccz L_cs_129
    s_add_u32 s48, s26, 20480
    s_mov_b32 m0, 126976
    s_nop 0
    buffer_load_dwordx4 v1, s[36:39], s48 offen offset:1024 sc1 lds
L_cs_129:
    v_cmp_eq_u32 vcc, -1, v30
    s_cbranch_vccz L_cs_130
    s_add_u32 s48, s26, 20480
    s_mov_b32 m0, 126976
    s_nop 0
    buffer_load_dwordx4 v1, s[36:39], s48 offen offset:2048 sc1 lds
L_cs_130:
    v_cmp_eq_u32 vcc, -1, v31
    s_cbranch_vccz L_cs_131
    s_add_u32 s48, s26, 20480
    s_mov_b32 m0, 126976
    s_nop 0
    buffer_load_dwordx4 v1, s[36:39], s48 offen offset:3072 sc1 lds
L_cs_131:
    v_cmp_eq_u32 vcc, -1, v32
    s_cbranch_vccz L_cs_132
    s_add_u32 s48, s26, 24576
    s_mov_b32 m0, 131072
    s_nop 0
    buffer_load_dwordx4 v1, s[36:39], s48 offen offset:0 sc1 lds
L_cs_132:
    v_cmp_eq_u32 vcc, -1, v33
    s_cbranch_vccz L_cs_133
    s_add_u32 s48, s26, 24576
    s_mov_b32 m0, 131072
    s_nop 0
    buffer_load_dwordx4 v1, s[36:39], s48 offen offset:1024 sc1 lds
L_cs_133:
    v_cmp_eq_u32 vcc, -1, v34
    s_cbranch_vccz L_cs_134
    s_add_u32 s48, s26, 24576
    s_mov_b32 m0, 131072
    s_nop 0
    buffer_load_dwordx4 v1, s[36:39], s48 offen offset:2048 sc1 lds
L_cs_134:
    v_cmp_eq_u32 vcc, -1, v35
    s_cbranch_vccz L_cs_135
    s_add_u32 s48, s26, 24576
    s_mov_b32 m0, 131072
    s_nop 0
    buffer_load_dwordx4 v1, s[36:39], s48 offen offset:3072 sc1 lds
L_cs_135:
    v_cmp_eq_u32 vcc, -1, v36
    s_cbranch_vccz L_cs_136
    s_add_u32 s48, s26, 28672
    s_mov_b32 m0, 135168
    s_nop 0
    buffer_load_dwordx4 v1, s[36:39], s48 offen offset:0 sc1 lds
L_cs_136:
    v_cmp_eq_u32 vcc, -1, v37
    s_cbranch_vccz L_cs_137
    s_add_u32 s48, s26, 28672
    s_mov_b32 m0, 135168
    s_nop 0
    buffer_load_dwordx4 v1, s[36:39], s48 offen offset:1024 sc1 lds
L_cs_137:
    v_cmp_eq_u32 vcc, -1, v38
    s_cbranch_vccz L_cs_138
    s_add_u32 s48, s26, 28672
    s_mov_b32 m0, 135168
    s_nop 0
    buffer_load_dwordx4 v1, s[36:39], s48 offen offset:2048 sc1 lds
L_cs_138:
    v_cmp_eq_u32 vcc, -1, v39
    s_cbranch_vccz L_cs_139
    s_add_u32 s48, s26, 28672
    s_mov_b32 m0, 135168
    s_nop 0
    buffer_load_dwordx4 v1, s[36:39], s48 offen offset:3072 sc1 lds
L_cs_139:
    s_waitcnt vmcnt(0)
    s_add_u32 s8, s8, 1
    s_cmp_lt_u32 s8, 400000
    s_cbranch_scc1 L_ck_105
    s_branch L_cd_107
L_w7:
    s_waitcnt lgkmcnt(0)
    s_add_u32 s48, s26, 0
    s_mov_b32 m0, 106496
    s_nop 0
    buffer_load_dwordx4 v1, s[36:39], s48 offen offset:0 sc1 lds
    buffer_load_dwordx4 v1, s[36:39], s48 offen offset:1024 sc1 lds
    buffer_load_dwordx4 v1, s[36:39], s48 offen offset:2048 sc1 lds
    buffer_load_dwordx4 v1, s[36:39], s48 offen offset:3072 sc1 lds
    s_add_u32 s48, s26, 4096
    s_mov_b32 m0, 110592
    s_nop 0
    buffer_load_dwordx4 v1, s[36:39], s48 offen offset:0 sc1 lds
    buffer_load_dwordx4 v1, s[36:39], s48 offen offset:1024 sc1 lds
    buffer_load_dwordx4 v1, s[36:39], s48 offen offset:2048 sc1 lds
    buffer_load_dwordx4 v1, s[36:39], s48 offen offset:3072 sc1 lds
    s_add_u32 s48, s26, 8192
    s_mov_b32 m0, 114688
    s_nop 0
    buffer_load_dwordx4 v1, s[36:39], s48 offen offset:0 sc1 lds
    buffer_load_dwordx4 v1, s[36:39], s48 offen offset:1024 sc1 lds
    buffer_load_dwordx4 v1, s[36:39], s48 offen offset:2048 sc1 lds
    buffer_load_dwordx4 v1, s[36:39], s48 offen offset:3072 sc1 lds
    s_add_u32 s48, s26, 12288
    s_mov_b32 m0, 118784
    s_nop 0
    buffer_load_dwordx4 v1, s[36:39], s48 offen offset:0 sc1 lds
    buffer_load_dwordx4 v1, s[36:39], s48 offen offset:1024 sc1 lds
    buffer_load_dwordx4 v1, s[36:39], s48 offen offset:2048 sc1 lds
    buffer_load_dwordx4 v1, s[36:39], s48 offen offset:3072 sc1 lds
    s_add_u32 s48, s26, 16384
    s_mov_b32 m0, 122880
    s_nop 0
    buffer_load_dwordx4 v1, s[36:39], s48 offen offset:0 sc1 lds
    buffer_load_dwordx4 v1, s[36:39], s48 offen offset:1024 sc1 lds
    buffer_load_dwordx4 v1, s[36:39], s48 offen offset:2048 sc1 lds
    buffer_load_dwordx4 v1, s[36:39], s48 offen offset:3072 sc1 lds
    s_waitcnt vmcnt(20)
L_ck_95:
    ds_read_b32 v72, v6 offset:0
    ds_read_b32 v73, v6 offset:1024
    ds_read_b32 v74, v6 offset:2048
    ds_read_b32 v75, v6 offset:3072
    s_waitcnt lgkmcnt(0)
    v_max_u32 v76, v72, v73
    v_max3_u32 v76, v76, v74, v75
    v_cmp_eq_u32 vcc, -1, v76
    s_cbranch_vccnz L_cr_96
L_cd_97:
    s_barrier
    s_add_u32 s48, s24, 0
    buffer_load_dwordx4 v[8:11], v1, s[36:39], s48 offen offset:0 sc1
    buffer_load_dwordx4 v[12:15], v1, s[36:39], s48 offen offset:1024 sc1
    buffer_load_dwordx4 v[16:19], v1, s[36:39], s48 offen offset:2048 sc1
    buffer_load_dwordx4 v[20:23], v1, s[36:39], s48 offen offset:3072 sc1
    s_add_u32 s48, s24, 4096
    buffer_load_dwordx4 v[24:27], v1, s[36:39], s48 offen offset:0 sc1
    buffer_load_dwordx4 v[28:31], v1, s[36:39], s48 offen offset:1024 sc1
    buffer_load_dwordx4 v[32:35], v1, s[36:39], s48 offen offset:2048 sc1
    buffer_load_dwordx4 v[36:39], v1, s[36:39], s48 offen offset:3072 sc1
    s_add_u32 s48, s24, 8192
    buffer_load_dwordx4 v[40:43], v1, s[36:39], s48 offen offset:0 sc1
    buffer_load_dwordx4 v[44:47], v1, s[36:39], s48 offen offset:1024 sc1
    buffer_load_dwordx4 v[48:51], v1, s[36:39], s48 offen offset:2048 sc1
    buffer_load_dwordx4 v[52:55], v1, s[36:39], s48 offen offset:3072 sc1
    s_add_u32 s48, s24, 12288
    buffer_load_dwordx4 v[56:59], v1, s[36:39], s48 offen offset:0 sc1
    buffer_load_dwordx4 v[60:63], v1, s[36:39], s48 offen offset:1024 sc1
    buffer_load_dwordx4 v[64:67], v1, s[36:39], s48 offen offset:2048 sc1
    buffer_load_dwordx4 v[68:71], v1, s[36:39], s48 offen offset:3072 sc1
    s_add_u32 s48, s26, 20480
    s_mov_b32 m0, 126976
    s_nop 0
    buffer_load_dwordx4 v1, s[36:39], s48 offen offset:0 sc1 lds
    buffer_load_dwordx4 v1, s[36:39], s48 offen offset:1024 sc1 lds
    buffer_load_dwordx4 v1, s[36:39], s48 offen offset:2048 sc1 lds
    buffer_load_dwordx4 v1, s[36:39], s48 offen offset:3072 sc1 lds
    s_add_u32 s48, s26, 24576
    s_mov_b32 m0, 131072
    s_nop 0
    buffer_load_dwordx4 v1, s[36:39], s48 offen offset:0 sc1 lds
    buffer_load_dwordx4 v1, s[36:39], s48 offen offset:1024 sc1 lds
    buffer_load_dwordx4 v1, s[36:39], s48 offen offset:2048 sc1 lds
    buffer_load_dwordx4 v1, s[36:39], s48 offen offset:3072 sc1 lds
    s_add_u32 s48, s26, 28672
    s_mov_b32 m0, 135168
    s_nop 0
    buffer_load_dwordx4 v1, s[36:39], s48 offen offset:0 sc1 lds
    buffer_load_dwordx4 v1, s[36:39], s48 offen offset:1024 sc1 lds
    buffer_load_dwordx4 v1, s[36:39], s48 offen offset:2048 sc1 lds
    buffer_load_dwordx4 v1, s[36:39], s48 offen offset:3072 sc1 lds
    s_waitcnt vmcnt(12)
L_chk_102:
    v_max_u32 v72, v8, v9
    v_max3_u32 v72, v72, v10, v11
    v_max3_u32 v72, v72, v12, v13
    v_max3_u32 v72, v72, v14, v15
    v_max3_u32 v72, v72, v16, v17
    v_max3_u32 v72, v72, v18, v19
    v_max3_u32 v72, v72, v20, v21
    v_max3_u32 v72, v72, v22, v23
    v_max3_u32 v72, v72, v24, v25
    v_max3_u32 v72, v72, v26, v27
    v_max3_u32 v72, v72, v28, v29
    v_max3_u32 v72, v72, v30, v31
    v_max3_u32 v72, v72, v32, v33
    v_max3_u32 v72, v72, v34, v35
    v_max3_u32 v72, v72, v36, v37
    v_max3_u32 v72, v72, v38, v39
    v_max3_u32 v72, v72, v40, v41
    v_max3_u32 v72, v72, v42, v43
    v_max3_u32 v72, v72, v44, v45
    v_max3_u32 v72, v72, v46, v47
    v_max3_u32 v72, v72, v48, v49
    v_max3_u32 v72, v72, v50, v51
    v_max3_u32 v72, v72, v52, v53
    v_max3_u32 v72, v72, v54, v55
    v_max3_u32 v72, v72, v56, v57
    v_max3_u32 v72, v72, v58, v59
    v_max3_u32 v72, v72, v60, v61
    v_max3_u32 v72, v72, v62, v63
    v_max3_u32 v72, v72, v64, v65
    v_max3_u32 v72, v72, v66, v67
    v_max3_u32 v72, v72, v68, v69
    v_max3_u32 v72, v72, v70, v71
    v_cmp_eq_u32 vcc, -1, v72
    s_nop 0
    s_cmp_lg_u64 vcc, 0
    s_cbranch_scc1 L_rty_103
L_ok_104:
    v_add_f32 v8, v8, v24
    v_add_f32 v9, v9, v25
    v_add_f32 v10, v10, v26
    v_add_f32 v11, v11, v27
    v_add_f32 v12, v12, v28
    v_add_f32 v13, v13, v29
    v_add_f32 v14, v14, v30
    v_add_f32 v15, v15, v31
    v_add_f32 v16, v16, v32
    v_add_f32 v17, v17, v33
    v_add_f32 v18, v18, v34
    v_add_f32 v19, v19, v35
    v_add_f32 v20, v20, v36
    v_add_f32 v21, v21, v37
    v_add_f32 v22, v22, v38
    v_add_f32 v23, v23, v39
    v_add_f32 v8, v8, v16
    v_add_f32 v9, v9, v17
    v_add_f32 v10, v10, v18
    v_add_f32 v11, v11, v19
    v_add_f32 v12, v12, v20
    v_add_f32 v13, v13, v21
    v_add_f32 v14, v14, v22
    v_add_f32 v15, v15, v23
    v_add_f32 v8, v8, v12
    v_add_f32 v9, v9, v13
    v_add_f32 v10, v10, v14
    v_add_f32 v11, v11, v15
    v_add_f32 v40, v40, v56
    v_add_f32 v41, v41, v57
    v_add_f32 v42, v42, v58
    v_add_f32 v43, v43, v59
    v_add_f32 v44, v44, v60
    v_add_f32 v45, v45, v61
    v_add_f32 v46, v46, v62
    v_add_f32 v47, v47, v63
    v_add_f32 v48, v48, v64
    v_add_f32 v49, v49, v65
    v_add_f32 v50, v50, v66
    v_add_f32 v51, v51, v67
    v_add_f32 v52, v52, v68
    v_add_f32 v53, v53, v69
    v_add_f32 v54, v54, v70
    v_add_f32 v55, v55, v71
    v_add_f32 v40, v40, v48
    v_add_f32 v41, v41, v49
    v_add_f32 v42, v42, v50
    v_add_f32 v43, v43, v51
    v_add_f32 v44, v44, v52
    v_add_f32 v45, v45, v53
    v_add_f32 v46, v46, v54
    v_add_f32 v47, v47, v55
    v_add_f32 v40, v40, v44
    v_add_f32 v41, v41, v45
    v_add_f32 v42, v42, v46
    v_add_f32 v43, v43, v47
    v_permlane32_swap_b32 v8, v10
    v_permlane32_swap_b32 v9, v11
    v_permlane32_swap_b32 v40, v42
    v_permlane32_swap_b32 v41, v43
    v_add_f32 v8, v8, v10
    v_add_f32 v9, v9, v11
    v_add_f32 v40, v40, v42
    v_add_f32 v41, v41, v43
    v_permlane16_swap_b32 v8, v9
    s_nop 0
    v_permlane16_swap_b32 v40, v41
    v_add_f32 v8, v8, v9
    v_add_f32 v40, v40, v41
    v_mul_f32 v8, 0.001953125, v8
    v_mul_f32 v40, 0.001953125, v40
    v_and_b32 v12, 15, v0
    v_lshlrev_b32 v12, 5, v12
    v_bfe_u32 v13, v0, 4, 2
    v_lshl_add_u32 v12, v13, 3, v12
    v_add_u32 v12, 69632, v12
    v_mov_b32_dpp v9, v8 row_ror:8 row_mask:0xf bank_mask:0xf
    v_mov_b32_dpp v41, v40 row_ror:8 row_mask:0xf bank_mask:0xf
    v_fma_f32 v9, -v8, v8, v9
    v_fma_f32 v41, -v40, v40, v41
    v_max_f32 v9, 0, v9
    v_max_f32 v41, 0, v41
    v_add_f32 v9, 1e-05, v9
    v_add_f32 v41, 1e-05, v41
    v_rsq_f32 v9, v9
    v_rsq_f32 v41, v41
    s_mov_b32 s50, 16711935
    s_mov_b32 s51, 16711935
    s_mov_b64 exec, s[50:51]
    ds_write_b64 v12, v[8:9] offset:0
    ds_write_b64 v12, v[40:41] offset:256
    s_mov_b64 exec, -1
    s_waitcnt vmcnt(0) lgkmcnt(0)
L_ck_105:
    ds_read_b32 v8, v5 offset:0
    ds_read_b32 v9, v5 offset:1024
    ds_read_b32 v10, v5 offset:2048
    ds_read_b32 v11, v5 offset:3072
    ds_read_b32 v12, v5 offset:4096
    ds_read_b32 v13, v5 offset:5120
    ds_read_b32 v14, v5 offset:6144
    ds_read_b32 v15, v5 offset:7168
    ds_read_b32 v16, v5 offset:8192
    ds_read_b32 v17, v5 offset:9216
    ds_read_b32 v18, v5 offset:10240
    ds_read_b32 v19, v5 offset:11264
    ds_read_b32 v20, v5 offset:12288
    ds_read_b32 v21, v5 offset:13312
    ds_read_b32 v22, v5 offset:14336
    ds_read_b32 v23, v5 offset:15360
    ds_read_b32 v24, v5 offset:16384
    ds_read_b32 v25, v5 offset:17408
    ds_read_b32 v26, v5 offset:18432
    ds_read_b32 v27, v5 offset:19456
    ds_read_b32 v28, v5 offset:20480
    ds_read_b32 v29, v5 offset:21504
    ds_read_b32 v30, v5 offset:22528
    ds_read_b32 v31, v5 offset:23552
    ds_read_b32 v32, v5 offset:24576
    ds_read_b32 v33, v5 offset:25600
    ds_read_b32 v34, v5 offset:26624
    ds_read_b32 v35, v5 offset:27648
    ds_read_b32 v36, v5 offset:28672
    ds_read_b32 v37, v5 offset:29696
    ds_read_b32 v38, v5 offset:30720
    ds_read_b32 v39, v5 offset:31744
    s_waitcnt lgkmcnt(0)
    v_max_u32 v40, v8, v9
    v_max3_u32 v40, v40, v10, v11
    v_max3_u32 v40, v40, v12, v13
    v_max3_u32 v40, v40, v14, v15
    v_max3_u32 v40, v40, v16, v17
    v_max3_u32 v40, v40, v18, v19
    v_max3_u32 v40, v40, v20, v21
    v_max3_u32 v40, v40, v22, v23
    v_max3_u32 v40, v40, v24, v25
    v_max3_u32 v40, v40, v26, v27
    v_max3_u32 v40, v40, v28, v29
    v_max3_u32 v40, v40, v30, v31
    v_max3_u32 v40, v40, v32, v33
    v_max3_u32 v40, v40, v34, v35
    v_max3_u32 v40, v40, v36, v37
    v_max3_u32 v40, v40, v38, v39
    v_cmp_eq_u32 vcc, -1, v40
    s_cbranch_vccnz L_cr_106
L_cd_107:
    s_barrier
    v_mov_b32 v72, v184
    v_mov_b32 v73, v185
    v_mov_b32 v74, v186
    v_mov_b32 v75, v187
    v_mov_b32 v76, v188
    v_mov_b32 v77, v189
    v_mov_b32 v78, v190
    v_mov_b32 v79, v191
    v_mov_b32 v80, v192
    v_mov_b32 v81, v193
    v_mov_b32 v82, v194
    v_mov_b32 v83, v195
    v_mov_b32 v84, v196
    v_mov_b32 v85, v197
    v_mov_b32 v86, v198
    v_mov_b32 v87, v199
    v_mov_b32 v88, v200
    v_mov_b32 v89, v201
    v_mov_b32 v90, v202
    v_mov_b32 v91, v203
    v_mov_b32 v92, v204
    v_mov_b32 v93, v205
    v_mov_b32 v94, v206
    v_mov_b32 v95, v207
    v_mov_b32 v96, v208
    v_mov_b32 v97, v209
    v_mov_b32 v98, v210
    v_mov_b32 v99, v211
    v_mov_b32 v100, v212
    v_mov_b32 v101, v213
    v_mov_b32 v102, v214
    v_mov_b32 v103, v215
    v_mov_b32 v104, v216
    v_mov_b32 v105, v217
    v_mov_b32 v106, v218
    v_mov_b32 v107, v219
    v_mov_b32 v108, v220
    v_mov_b32 v109, v221
    v_mov_b32 v110, v222
    v_mov_b32 v111, v223
    v_mov_b32 v112, v224
    v_mov_b32 v113, v225
    v_mov_b32 v114, v226
    v_mov_b32 v115, v227
    v_mov_b32 v116, v228
    v_mov_b32 v117, v229
    v_mov_b32 v118, v230
    v_mov_b32 v119, v231
    v_mov_b32 v120, v232
    v_mov_b32 v121, v233
    v_mov_b32 v122, v234
    v_mov_b32 v123, v235
    v_mov_b32 v124, v236
    v_mov_b32 v125, v237
    v_mov_b32 v126, v238
    v_mov_b32 v127, v239
    v_mov_b32 v128, v240
    v_mov_b32 v129, v241
    v_mov_b32 v130, v242
    v_mov_b32 v131, v243
    v_mov_b32 v132, v244
    v_mov_b32 v133, v245
    v_mov_b32 v134, v246
    v_mov_b32 v135, v247
    s_barrier
    buffer_load_dwordx4 v[216:219], v1, s[36:39], s28 offen offset:0 sc1
    buffer_load_dwordx4 v[220:223], v1, s[36:39], s28 offen offset:1024 sc1
    buffer_load_dwordx4 v[224:227], v1, s[36:39], s28 offen offset:2048 sc1
    buffer_load_dwordx4 v[228:231], v1, s[36:39], s28 offen offset:3072 sc1
    s_add_u32 s28, s28, 4096
    buffer_load_dwordx4 v[232:235], v1, s[36:39], s28 offen offset:0 sc1
    buffer_load_dwordx4 v[236:239], v1, s[36:39], s28 offen offset:1024 sc1
    s_branch L_p4done
L_rty_141:
    s_add_u32 s48, s29, 0
    buffer_load_dwordx4 v[216:219], v1, s[36:39], s48 offen sc1
    s_waitcnt vmcnt(0)
    s_add_u32 s8, s8, 1
    s_cmp_lt_u32 s8, 400000
    s_cbranch_scc1 L_chk_140
    s_branch L_ok_142
L_rty_144:
    s_add_u32 s48, s29, 1024
    buffer_load_dwordx4 v[220:223], v1, s[36:39], s48 offen sc1
    s_waitcnt vmcnt(0)
    s_add_u32 s8, s8, 1
    s_cmp_lt_u32 s8, 400000
    s_cbranch_scc1 L_chk_143
    s_branch L_ok_145
L_rty_147:
    s_add_u32 s48, s29, 2048
    buffer_load_dwordx4 v[224:227], v1, s[36:39], s48 offen sc1
    s_waitcnt vmcnt(0)
    s_add_u32 s8, s8, 1
    s_cmp_lt_u32 s8, 400000
    s_cbranch_scc1 L_chk_146
    s_branch L_ok_148
L_rty_150:
    s_add_u32 s48, s29, 3072
    buffer_load_dwordx4 v[228:231], v1, s[36:39], s48 offen sc1
    s_waitcnt vmcnt(0)
    s_add_u32 s8, s8, 1
    s_cmp_lt_u32 s8, 400000
    s_cbranch_scc1 L_chk_149
    s_branch L_ok_151
L_rty_153:
    s_add_u32 s48, s29, 4096
    buffer_load_dwordx4 v[232:235], v1, s[36:39], s48 offen sc1
    s_waitcnt vmcnt(0)
    s_add_u32 s8, s8, 1
    s_cmp_lt_u32 s8, 400000
    s_cbranch_scc1 L_chk_152
    s_branch L_ok_154
L_rty_156:
    s_add_u32 s48, s29, 5120
    buffer_load_dwordx4 v[236:239], v1, s[36:39], s48 offen sc1
    s_waitcnt vmcnt(0)
    s_add_u32 s8, s8, 1
    s_cmp_lt_u32 s8, 400000
    s_cbranch_scc1 L_chk_155
    s_branch L_ok_157
L_rty_159:
    s_add_u32 s48, s29, 6144
    buffer_load_dwordx4 v[184:187], v1, s[36:39], s48 offen sc1
    s_waitcnt vmcnt(0)
    s_add_u32 s8, s8, 1
    s_cmp_lt_u32 s8, 400000
    s_cbranch_scc1 L_chk_158
    s_branch L_ok_160
L_rty_162:
    s_add_u32 s48, s29, 7168
    buffer_load_dwordx4 v[188:191], v1, s[36:39], s48 offen sc1
    s_waitcnt vmcnt(0)
    s_add_u32 s8, s8, 1
    s_cmp_lt_u32 s8, 400000
    s_cbranch_scc1 L_chk_161
    s_branch L_ok_163
L_rty_165:
    s_add_u32 s48, s29, 8192
    buffer_load_dwordx4 v[192:195], v1, s[36:39], s48 offen sc1
    s_waitcnt vmcnt(0)
    s_add_u32 s8, s8, 1
    s_cmp_lt_u32 s8, 400000
    s_cbranch_scc1 L_chk_164
    s_branch L_ok_166
L_rty_168:
    s_add_u32 s48, s29, 9216
    buffer_load_dwordx4 v[196:199], v1, s[36:39], s48 offen sc1
    s_waitcnt vmcnt(0)
    s_add_u32 s8, s8, 1
    s_cmp_lt_u32 s8, 400000
    s_cbranch_scc1 L_chk_167
    s_branch L_ok_169
L_rty_171:
    s_add_u32 s48, s29, 10240
    buffer_load_dwordx4 v[200:203], v1, s[36:39], s48 offen sc1
    s_waitcnt vmcnt(0)
    s_add_u32 s8, s8, 1
    s_cmp_lt_u32 s8, 400000
    s_cbranch_scc1 L_chk_170
    s_branch L_ok_172
L_rty_174:
    s_add_u32 s48, s29, 11264
    buffer_load_dwordx4 v[204:207], v1, s[36:39], s48 offen sc1
    s_waitcnt vmcnt(0)
    s_add_u32 s8, s8, 1
    s_cmp_lt_u32 s8, 400000
    s_cbranch_scc1 L_chk_173
    s_branch L_ok_175
L_rty_177:
    s_add_u32 s48, s29, 12288
    buffer_load_dwordx4 v[208:211], v1, s[36:39], s48 offen sc1
    s_waitcnt vmcnt(0)
    s_add_u32 s8, s8, 1
    s_cmp_lt_u32 s8, 400000
    s_cbranch_scc1 L_chk_176
    s_branch L_ok_178
L_rty_180:
    s_add_u32 s48, s29, 13312
    buffer_load_dwordx4 v[212:215], v1, s[36:39], s48 offen sc1
    s_waitcnt vmcnt(0)
    s_add_u32 s8, s8, 1
    s_cmp_lt_u32 s8, 400000
    s_cbranch_scc1 L_chk_179
    s_branch L_ok_181
L_rty_183:
    s_add_u32 s48, s29, 14336
    buffer_load_dwordx4 v[240:243], v1, s[36:39], s48 offen sc1
    s_waitcnt vmcnt(0)
    s_add_u32 s8, s8, 1
    s_cmp_lt_u32 s8, 400000
    s_cbranch_scc1 L_chk_182
    s_branch L_ok_184
L_rty_186:
    s_add_u32 s48, s29, 15360
    buffer_load_dwordx4 v[244:247], v1, s[36:39], s48 offen sc1
    s_waitcnt vmcnt(0)
    s_add_u32 s8, s8, 1
    s_cmp_lt_u32 s8, 400000
    s_cbranch_scc1 L_chk_185
    s_branch L_ok_187
L_rty_189:
    s_add_u32 s48, s29, 16384
    buffer_load_dwordx4 v[248:251], v1, s[36:39], s48 offen sc1
    s_waitcnt vmcnt(0)
    s_add_u32 s8, s8, 1
    s_cmp_lt_u32 s8, 400000
    s_cbranch_scc1 L_chk_188
    s_branch L_ok_190
L_rty_192:
    s_add_u32 s48, s29, 17408
    buffer_load_dwordx4 v[252:255], v1, s[36:39], s48 offen sc1
    s_waitcnt vmcnt(0)
    s_add_u32 s8, s8, 1
    s_cmp_lt_u32 s8, 400000
    s_cbranch_scc1 L_chk_191
    s_branch L_ok_193
L_rty_195:
    s_add_u32 s48, s29, 18432
    buffer_load_dwordx4 v[40:43], v1, s[36:39], s48 offen sc1
    s_waitcnt vmcnt(0)
    s_add_u32 s8, s8, 1
    s_cmp_lt_u32 s8, 400000
    s_cbranch_scc1 L_chk_194
    s_branch L_ok_196
L_rty_198:
    s_add_u32 s48, s29, 19456
    buffer_load_dwordx4 v[44:47], v1, s[36:39], s48 offen sc1
    s_waitcnt vmcnt(0)
    s_add_u32 s8, s8, 1
    s_cmp_lt_u32 s8, 400000
    s_cbranch_scc1 L_chk_197
    s_branch L_ok_199
L_rty_201:
    s_add_u32 s48, s29, 20480
    buffer_load_dwordx4 v[48:51], v1, s[36:39], s48 offen sc1
    s_waitcnt vmcnt(0)
    s_add_u32 s8, s8, 1
    s_cmp_lt_u32 s8, 400000
    s_cbranch_scc1 L_chk_200
    s_branch L_ok_202
L_cr_204:
    v_cmp_eq_u32 vcc, -1, v68
    s_cbranch_vccz L_cs_206
    buffer_load_dwordx2 v[68:69], v66, s[36:39], s31 offen sc1
L_cs_206:
    v_cmp_eq_u32 vcc, -1, v70
    s_cbranch_vccz L_cs_207
    buffer_load_dwordx2 v[70:71], v66, s[36:39], s18 offen sc1
L_cs_207:
    s_waitcnt vmcnt(0)
    s_add_u32 s8, s8, 1
    s_cmp_lt_u32 s8, 400000
    s_cbranch_scc1 L_ck_203
    s_branch L_cd_205
L_rty_209:
    s_add_u32 s48, s29, 21504
    buffer_load_dwordx4 v[52:55], v1, s[36:39], s48 offen sc1
    s_waitcnt vmcnt(0)
    s_add_u32 s8, s8, 1
    s_cmp_lt_u32 s8, 400000
    s_cbranch_scc1 L_chk_208
    s_branch L_ok_210
L_rty_212:
    s_add_u32 s48, s29, 22528
    buffer_load_dwordx4 v[56:59], v1, s[36:39], s48 offen sc1
    s_waitcnt vmcnt(0)
    s_add_u32 s8, s8, 1
    s_cmp_lt_u32 s8, 400000
    s_cbranch_scc1 L_chk_211
    s_branch L_ok_213
L_rty_215:
    s_add_u32 s48, s29, 23552
    buffer_load_dwordx4 v[60:63], v1, s[36:39], s48 offen sc1
    s_waitcnt vmcnt(0)
    s_add_u32 s8, s8, 1
    s_cmp_lt_u32 s8, 400000
    s_cbranch_scc1 L_chk_214
    s_branch L_ok_216
L_rty_218:
    s_add_u32 s48, s29, 24576
    buffer_load_dwordx4 v[216:219], v1, s[36:39], s48 offen sc1
    s_waitcnt vmcnt(0)
    s_add_u32 s8, s8, 1
    s_cmp_lt_u32 s8, 400000
    s_cbranch_scc1 L_chk_217
    s_branch L_ok_219
L_rty_221:
    s_add_u32 s48, s29, 25600
    buffer_load_dwordx4 v[220:223], v1, s[36:39], s48 offen sc1
    s_waitcnt vmcnt(0)
    s_add_u32 s8, s8, 1
    s_cmp_lt_u32 s8, 400000
    s_cbranch_scc1 L_chk_220
    s_branch L_ok_222
L_rty_224:
    s_add_u32 s48, s29, 26624
    buffer_load_dwordx4 v[224:227], v1, s[36:39], s48 offen sc1
    s_waitcnt vmcnt(0)
    s_add_u32 s8, s8, 1
    s_cmp_lt_u32 s8, 400000
    s_cbranch_scc1 L_chk_223
    s_branch L_ok_225
L_rty_227:
    s_add_u32 s48, s29, 27648
    buffer_load_dwordx4 v[228:231], v1, s[36:39], s48 offen sc1
    s_waitcnt vmcnt(0)
    s_add_u32 s8, s8, 1
    s_cmp_lt_u32 s8, 400000
    s_cbranch_scc1 L_chk_226
    s_branch L_ok_228
L_end:
    s_endpgm
.section .rodata,"a"
.p2align 6
.amdhsa_kernel adaLN_cond__mha_block__dense_activation_relu__prompt_kernel
  .amdhsa_next_free_vgpr 256
  .amdhsa_next_free_sgpr 102
  .amdhsa_accum_offset 256
  .amdhsa_group_segment_fixed_size 0
  .amdhsa_kernarg_size 88
  .amdhsa_user_sgpr_count 2
  .amdhsa_user_sgpr_kernarg_segment_ptr 1
  .amdhsa_system_sgpr_workgroup_id_x 1
.end_amdhsa_kernel
```
